```python
import torch

def _softmax(x, axis=-1):
    return torch.softmax(x, dim=axis)
def _gelu(x):
    return torch.nn.functional.gelu(x, approximate="tanh")
def _silu(x):
    return torch.nn.functional.silu(x)
def _sigmoid(x):
    return torch.sigmoid(x)
def _layernorm(x, axis=-1, eps=1e-5):
    m = x.mean(dim=axis, keepdim=True)
    v = x.var(dim=axis, keepdim=True, unbiased=False)
    return (x - m) / torch.sqrt(v + eps)
def _scatter_add(tgt, idx, src, axis=0):
    return tgt.clone().index_add_(axis, idx, src)
def _segment_sum(src, seg, n):
    out = torch.zeros((n,) + src.shape[1:], dtype=src.dtype)
    return out.index_add_(0, seg, src)
def _pad(x, pw):
    flat = tuple(v for pair in reversed(pw) for v in pair)
    return torch.nn.functional.pad(x, flat)

kernel_name = 'standalone__batchnorm__prompt'

def setup_inputs():

    _w = (lambda a: (lambda t: t.to(torch.bfloat16) if t.is_floating_point() else t)(torch.as_tensor(a)))
    B, S, C = 2, 2048, 1024
    K = 3
    return {
        "x": _w((lambda *s: torch.randn(*s, dtype=torch.bfloat16) * 0.05)(B, S, C)),
        "w": _w((lambda *s: torch.randn(*s, dtype=torch.bfloat16) * 0.05)(K, C, C) * (1.0 / (K * C) ** 0.5)),
        "mean": _w((lambda *s: torch.randn(*s, dtype=torch.bfloat16) * 0.05)(C) * 0.1),
        "var": _w(torch.abs((lambda *s: torch.randn(*s, dtype=torch.bfloat16) * 0.05)(C)) + 0.5),
        "g": _w((lambda *s: torch.randn(*s, dtype=torch.bfloat16) * 0.05)(C) + 1.0),
        "b": _w((lambda *s: torch.randn(*s, dtype=torch.bfloat16) * 0.05)(C) * 0.1),
    }

def reference(x, w, mean, var, g, b):
    K = 3
    P = K // 2
    S = x.shape[1]
    xp = _pad(x, ((0, 0), (P, P), (0, 0)))
    y = sum(torch.einsum('bsc,cd->bsd', xp[:, k:k + S, :], w[k]) for k in range(K))
    inv_std = 1.0 / torch.sqrt(var + 1e-5)
    y = (y - mean) * (g * inv_std) + b
    return _silu(y)
```

```asm
; @launch grid=(256,1,1) block=(512,1,1) lds=162944
.amdgcn_target "amdgcn-amd-amdhsa--gfx950"
.text
.globl standalone__batchnorm__prompt_kernel
.p2align 12
.p2align 8
.type standalone__batchnorm__prompt_kernel,@function
standalone__batchnorm__prompt_kernel:
    s_cmp_ge_u32 s2, 256
    s_cbranch_scc1 L_end
    v_readfirstlane_b32 s18, v0
    s_load_dwordx2 s[8:9], s[0:1], 8
    s_load_dwordx2 s[4:5], s[0:1], 0
    s_bfe_u32 s3, s18, 0x50003
    s_load_dwordx2 s[12:13], s[0:1], s3 offset:16
    v_and_b32 v0, 63, v0
    s_lshr_b32 s17, s2, 5
    s_and_b32 s20, s2, 1
    s_lshl3_add_u32 s17, s20, s17
    s_bfe_u32 s22, s2, 0x20001
    s_bfe_u32 s16, s2, 0x20003
    s_lshl2_add_u32 s16, s22, s16
    s_lshr_b32 s18, s18, 6
    s_lshl_b32 s17, s17, 6
    s_lshl_b32 s16, s16, 8
    s_cmp_ge_u32 s18, 4
    s_cbranch_scc0 L_loader
    s_cmp_lg_u32 s18, 7
    s_cbranch_scc0 L_compute
    s_cmp_lg_u32 s18, 6
    s_cbranch_scc0 L_touch3
    s_cmp_lg_u32 s18, 5
    s_cbranch_scc0 L_touch2
    s_cmp_lg_u32 s18, 4
    s_cbranch_scc0 L_touch1
    s_branch L_compute
L_loader:
    v_lshrrev_b32 v5, 3, v0
    s_lshl_b32 s47, s18, 2
    v_xor_b32 v6, s47, v0
    s_xor_b32 s84, s22, s20
    v_and_b32 v7, 2, v5
    v_and_b32 v6, 7, v6
    s_and_b32 s3, s84, 1
    s_xor_b32 s3, s3, 4
    s_lshl_b32 s85, s2, 13
    v_xor_b32 v7, v7, v6
    s_and_b32 s85, s85, 0x10000
    s_lshl_b32 s42, s3, 17
    v_lshlrev_b32 v7, 4, v7
    s_or_b32 s42, s42, s85
    s_lshl_b32 s50, s18, 10
    v_lshl_add_u32 v4, v5, 11, v7
    s_lshl3_add_u32 s45, s50, s17
    s_add_u32 s51, s50, 100992
    v_lshl_add_u32 v4, s45, 1, v4
    s_mov_b32 s10, 0x600000
    s_mov_b32 s11, 0x20000
    s_mov_b32 s43, s51
    s_mov_b32 s38, 0x200000
    s_movk_i32 s39, 4096
    s_add_u32 s49, s51, 61440
    s_lshl_b32 s40, s3, 7
    v_lshl_add_u32 v8, v0, 1, s17
    s_movk_i32 s14, 2048
    s_mov_b32 s15, s11
    v_lshlrev_b32 v8, 1, v8
    s_lshl_b32 s3, s18, 7
    s_add_u32 m0, s3, 162432
    s_mov_b32 exec_hi, 0
    s_waitcnt lgkmcnt(0)
    buffer_load_dword v8, s[12:15], 0 offen lds
    s_mov_b32 exec_hi, -1
    s_mov_b32 m0, s43
    s_add_u32 s45, s42, s38
    buffer_load_dwordx4 v4, s[8:11], s42 offen  lds
    s_add_u32 m0, m0, s39
    s_add_u32 s46, s45, s38
    buffer_load_dwordx4 v4, s[8:11], s45 offen  lds
    s_add_u32 m0, m0, s39
    s_addk_i32 s43, 12288
    buffer_load_dwordx4 v4, s[8:11], s46 offen  lds
    s_cmp_ge_u32 s43, s49
    s_cselect_b32 s43, s51, s43
    s_xor_b32 s42, s42, 0x10000
    v_lshrrev_b32 v7, 1, v5
    s_mov_b32 s6, 0x800000
    v_xor_b32 v7, v7, v6
    s_mov_b32 s7, s11
    v_lshlrev_b32 v7, 4, v7
    s_lshl4_add_u32 s3, s47, s16
    v_lshl_add_u32 v2, v5, 14, v7
    s_bitcmp1_b32 s17, 6
    s_cselect_b32 s86, 16896, 0
    v_lshl_add_u32 v2, s3, 11, v2
    s_cselect_b32 s88, 0x2000, 0
    s_add_u32 s41, s50, 33664
    s_movk_i32 s53, 2048
    s_movk_i32 s54, 4224
    s_add_u32 m0, s41, s86
    s_add_u32 s45, s40, s88
    buffer_load_dwordx4 v2, s[4:7], s45 offen  lds
    s_add_u32 m0, m0, s54
    s_add_u32 s46, s45, s53
    buffer_load_dwordx4 v2, s[4:7], s46 offen  lds
    s_add_u32 m0, m0, s54
    s_add_u32 s45, s46, s53
    buffer_load_dwordx4 v2, s[4:7], s45 offen  lds
    s_add_u32 m0, m0, s54
    s_add_u32 s46, s45, s53
    buffer_load_dwordx4 v2, s[4:7], s46 offen  lds
    s_xor_b32 s87, s86, 16896
    s_xor_b32 s89, s88, 0x2000
    s_movk_i32 s44, 29440
    s_cmp_lt_u32 s18, 2
    s_cselect_b32 s3, 256, 0
    s_cselect_b32 s23, 256, -1
    s_cselect_b32 s24, 0, 7
    s_cmovk_i32 s44, 4096
    s_add_u32 s3, s3, s16
    s_add_u32 s23, s23, s16
    s_lshl_b32 s23, s23, 11
    s_and_b32 s3, s3, 2047
    s_cselect_b32 s23, s23, 0x80000000
    v_xor_b32 v7, s24, v6
    s_and_b32 s47, s47, 4
    v_lshl_add_u32 v3, v7, 4, s23
    s_lshl4_add_u32 s44, s47, s44
    s_sub_u32 s44, s44, s50
    s_add_u32 m0, s41, s44
    s_mov_b64 exec, 15
    buffer_load_dwordx4 v3, s[4:7], s40 offen  lds
    s_mov_b64 exec, -1
    s_add_u32 m0, s41, s87
    s_add_u32 s45, s40, s89
    buffer_load_dwordx4 v2, s[4:7], s45 offen  lds
    s_add_u32 m0, m0, s54
    s_add_u32 s46, s45, s53
    buffer_load_dwordx4 v2, s[4:7], s46 offen  lds
    s_add_u32 m0, m0, s54
    s_add_u32 s45, s46, s53
    buffer_load_dwordx4 v2, s[4:7], s45 offen  lds
    s_add_u32 m0, m0, s54
    s_add_u32 s46, s45, s53
    buffer_load_dwordx4 v2, s[4:7], s46 offen  lds
    s_add_u32 s41, s41, 33664
    s_cmp_ge_u32 s41, s51
    s_cselect_b32 s41, s50, s41
    s_mov_b32 m0, s43
    s_add_u32 s45, s42, s38
    buffer_load_dwordx4 v4, s[8:11], s42 offen  lds
    s_add_u32 m0, m0, s39
    s_add_u32 s46, s45, s38
    buffer_load_dwordx4 v4, s[8:11], s45 offen  lds
    s_waitcnt vmcnt(14)
    s_barrier
    s_add_u32 m0, m0, s39
    s_addk_i32 s43, 12288
    buffer_load_dwordx4 v4, s[8:11], s46 offen  lds
    s_cmp_ge_u32 s43, s49
    s_cselect_b32 s43, s51, s43
    s_mul_i32 s3, s84, 0x11111111
    s_and_b32 s82, s3, 0x33331111
    s_xor_b32 s82, s82, 0xba987654
    s_xor_b32 s83, s3, 0xfedc3210
    s_lshr_b64 s[82:83], s[82:83], 4
    s_and_b32 s3, s82, 15
    s_lshl_b32 s40, s3, 7
    s_lshl_b32 s42, s3, 17
    s_or_b32 s42, s42, s85
    s_mov_b32 m0, s43
    s_add_u32 s45, s42, s38
    buffer_load_dwordx4 v4, s[8:11], s42 offen  lds
    s_add_u32 m0, m0, s39
    s_add_u32 s46, s45, s38
    buffer_load_dwordx4 v4, s[8:11], s45 offen  lds
    s_add_u32 m0, m0, s39
    s_addk_i32 s43, 12288
    buffer_load_dwordx4 v4, s[8:11], s46 offen  lds
    s_cmp_ge_u32 s43, s49
    s_cselect_b32 s43, s51, s43
    s_xor_b32 s42, s42, 0x10000
    s_add_u32 m0, s41, s86
    s_add_u32 s45, s40, s88
    buffer_load_dwordx4 v2, s[4:7], s45 offen  lds
    s_add_u32 m0, m0, s54
    s_add_u32 s46, s45, s53
    buffer_load_dwordx4 v2, s[4:7], s46 offen  lds
    s_add_u32 m0, m0, s54
    s_add_u32 s45, s46, s53
    buffer_load_dwordx4 v2, s[4:7], s45 offen  lds
    s_waitcnt vmcnt(9)
    s_barrier
    s_add_u32 m0, m0, s54
    s_add_u32 s46, s45, s53
    buffer_load_dwordx4 v2, s[4:7], s46 offen  lds
    s_add_u32 m0, s41, s44
    s_mov_b64 exec, 15
    buffer_load_dwordx4 v3, s[4:7], s40 offen  lds
    s_mov_b64 exec, -1
    s_add_u32 m0, s41, s87
    s_add_u32 s45, s40, s89
    buffer_load_dwordx4 v2, s[4:7], s45 offen  lds
    s_add_u32 m0, m0, s54
    s_add_u32 s46, s45, s53
    buffer_load_dwordx4 v2, s[4:7], s46 offen  lds
    s_add_u32 m0, m0, s54
    s_add_u32 s45, s46, s53
    buffer_load_dwordx4 v2, s[4:7], s45 offen  lds
    s_add_u32 m0, m0, s54
    s_add_u32 s46, s45, s53
    buffer_load_dwordx4 v2, s[4:7], s46 offen  lds
    s_add_u32 s41, s41, 33664
    s_cmp_ge_u32 s41, s51
    s_cselect_b32 s41, s50, s41
    s_waitcnt vmcnt(12)
    s_barrier
    s_mov_b32 m0, s43
    s_add_u32 s45, s42, s38
    buffer_load_dwordx4 v4, s[8:11], s42 offen  lds
    s_add_u32 m0, m0, s39
    s_add_u32 s46, s45, s38
    buffer_load_dwordx4 v4, s[8:11], s45 offen  lds
    s_add_u32 m0, m0, s39
    s_addk_i32 s43, 12288
    buffer_load_dwordx4 v4, s[8:11], s46 offen  lds
    s_cmp_ge_u32 s43, s49
    s_cselect_b32 s43, s51, s43
    s_lshr_b64 s[82:83], s[82:83], 4
    s_and_b32 s3, s82, 15
    s_lshl_b32 s40, s3, 7
    s_lshl_b32 s42, s3, 17
    s_or_b32 s42, s42, s85
    s_mov_b32 m0, s43
    s_add_u32 s45, s42, s38
    buffer_load_dwordx4 v4, s[8:11], s42 offen  lds
    s_add_u32 m0, m0, s39
    s_add_u32 s46, s45, s38
    buffer_load_dwordx4 v4, s[8:11], s45 offen  lds
    s_add_u32 m0, m0, s39
    s_addk_i32 s43, 12288
    buffer_load_dwordx4 v4, s[8:11], s46 offen  lds
    s_cmp_ge_u32 s43, s49
    s_cselect_b32 s43, s51, s43
    s_xor_b32 s42, s42, 0x10000
    s_add_u32 m0, s41, s86
    s_add_u32 s45, s40, s88
    buffer_load_dwordx4 v2, s[4:7], s45 offen  lds
    s_add_u32 m0, m0, s54
    s_add_u32 s46, s45, s53
    buffer_load_dwordx4 v2, s[4:7], s46 offen  lds
    s_waitcnt vmcnt(8)
    s_barrier
    s_add_u32 m0, m0, s54
    s_add_u32 s45, s46, s53
    buffer_load_dwordx4 v2, s[4:7], s45 offen  lds
    s_add_u32 m0, m0, s54
    s_add_u32 s46, s45, s53
    buffer_load_dwordx4 v2, s[4:7], s46 offen  lds
    s_add_u32 m0, s41, s44
    s_mov_b64 exec, 15
    buffer_load_dwordx4 v3, s[4:7], s40 offen  lds
    s_mov_b64 exec, -1
    s_add_u32 m0, s41, s87
    s_add_u32 s45, s40, s89
    buffer_load_dwordx4 v2, s[4:7], s45 offen  lds
    s_add_u32 m0, m0, s54
    s_add_u32 s46, s45, s53
    buffer_load_dwordx4 v2, s[4:7], s46 offen  lds
    s_add_u32 m0, m0, s54
    s_add_u32 s45, s46, s53
    buffer_load_dwordx4 v2, s[4:7], s45 offen  lds
    s_add_u32 m0, m0, s54
    s_add_u32 s46, s45, s53
    buffer_load_dwordx4 v2, s[4:7], s46 offen  lds
    s_add_u32 s41, s41, 33664
    s_cmp_ge_u32 s41, s51
    s_cselect_b32 s41, s50, s41
    s_mov_b32 m0, s43
    s_add_u32 s45, s42, s38
    buffer_load_dwordx4 v4, s[8:11], s42 offen  lds
    s_mov_b32 s52, 4
    s_mov_b64 vcc, -1
L_lloop:
    s_waitcnt vmcnt(13)
    s_barrier
    s_add_u32 m0, m0, s39
    s_add_u32 s46, s45, s38
    buffer_load_dwordx4 v4, s[8:11], s45 offen  lds
    s_add_u32 m0, m0, s39
    s_addk_i32 s43, 12288
    buffer_load_dwordx4 v4, s[8:11], s46 offen  lds
    s_cmp_ge_u32 s43, s49
    s_cselect_b32 s43, s51, s43
    s_lshr_b64 s[82:83], s[82:83], 4
    s_and_b32 s3, s82, 15
    s_lshl_b32 s40, s3, 7
    s_lshl_b32 s42, s3, 17
    s_or_b32 s42, s42, s85
    s_mov_b32 m0, s43
    s_add_u32 s45, s42, s38
    buffer_load_dwordx4 v4, s[8:11], s42 offen  lds
    s_add_u32 m0, m0, s39
    s_add_u32 s46, s45, s38
    buffer_load_dwordx4 v4, s[8:11], s45 offen  lds
    s_add_u32 m0, m0, s39
    s_addk_i32 s43, 12288
    buffer_load_dwordx4 v4, s[8:11], s46 offen  lds
    s_cmp_ge_u32 s43, s49
    s_cselect_b32 s43, s51, s43
    s_xor_b32 s42, s42, 0x10000
    s_add_u32 m0, s41, s86
    s_add_u32 s45, s40, s88
    buffer_load_dwordx4 v2, s[4:7], s45 offen  lds
    s_add_u32 m0, m0, s54
    s_add_u32 s46, s45, s53
    buffer_load_dwordx4 v2, s[4:7], s46 offen  lds
    s_add_u32 m0, m0, s54
    s_add_u32 s45, s46, s53
    buffer_load_dwordx4 v2, s[4:7], s45 offen  lds
    s_add_u32 m0, m0, s54
    s_add_u32 s46, s45, s53
    buffer_load_dwordx4 v2, s[4:7], s46 offen  lds
    s_add_u32 m0, s41, s44
    s_mov_b64 exec, 15
    buffer_load_dwordx4 v3, s[4:7], s40 offen  lds
    s_mov_b64 exec, -1
    s_waitcnt vmcnt(11)
    s_barrier
    s_add_u32 m0, s41, s87
    s_add_u32 s45, s40, s89
    buffer_load_dwordx4 v2, s[4:7], s45 offen  lds
    s_add_u32 m0, m0, s54
    s_add_u32 s46, s45, s53
    buffer_load_dwordx4 v2, s[4:7], s46 offen  lds
    s_add_u32 m0, m0, s54
    s_add_u32 s45, s46, s53
    buffer_load_dwordx4 v2, s[4:7], s45 offen  lds
    s_add_u32 m0, m0, s54
    s_add_u32 s46, s45, s53
    buffer_load_dwordx4 v2, s[4:7], s46 offen  lds
    s_add_u32 s41, s41, 33664
    s_cmp_ge_u32 s41, s51
    s_cselect_b32 s41, s50, s41
    s_mov_b32 m0, s43
    s_add_u32 s45, s42, s38
    buffer_load_dwordx4 v4, s[8:11], s42 offen  lds
    s_add_u32 m0, m0, s39
    s_add_u32 s46, s45, s38
    buffer_load_dwordx4 v4, s[8:11], s45 offen  lds
    s_add_u32 m0, m0, s39
    s_addk_i32 s43, 12288
    buffer_load_dwordx4 v4, s[8:11], s46 offen  lds
    s_cmp_ge_u32 s43, s49
    s_cselect_b32 s43, s51, s43
    s_lshr_b64 s[82:83], s[82:83], 4
    s_and_b32 s3, s82, 15
    s_lshl_b32 s40, s3, 7
    s_lshl_b32 s42, s3, 17
    s_or_b32 s42, s42, s85
    s_mov_b32 m0, s43
    s_add_u32 s45, s42, s38
    buffer_load_dwordx4 v4, s[8:11], s42 offen  lds
    s_add_u32 m0, m0, s39
    s_add_u32 s46, s45, s38
    buffer_load_dwordx4 v4, s[8:11], s45 offen  lds
    s_waitcnt vmcnt(17)
    s_barrier
    s_add_u32 m0, m0, s39
    s_addk_i32 s43, 12288
    buffer_load_dwordx4 v4, s[8:11], s46 offen  lds
    s_cmp_ge_u32 s43, s49
    s_cselect_b32 s43, s51, s43
    s_xor_b32 s42, s42, 0x10000
    s_add_u32 m0, s41, s86
    s_add_u32 s45, s40, s88
    buffer_load_dwordx4 v2, s[4:7], s45 offen  lds
    s_add_u32 m0, m0, s54
    s_add_u32 s46, s45, s53
    buffer_load_dwordx4 v2, s[4:7], s46 offen  lds
    s_add_u32 m0, m0, s54
    s_add_u32 s45, s46, s53
    buffer_load_dwordx4 v2, s[4:7], s45 offen  lds
    s_add_u32 m0, m0, s54
    s_add_u32 s46, s45, s53
    buffer_load_dwordx4 v2, s[4:7], s46 offen  lds
    s_add_u32 m0, s41, s44
    s_mov_b64 exec, 15
    buffer_load_dwordx4 v3, s[4:7], s40 offen  lds
    s_mov_b64 exec, -1
    s_add_u32 m0, s41, s87
    s_add_u32 s45, s40, s89
    buffer_load_dwordx4 v2, s[4:7], s45 offen  lds
    s_waitcnt vmcnt(12)
    s_barrier
    s_add_u32 m0, m0, s54
    s_add_u32 s46, s45, s53
    buffer_load_dwordx4 v2, s[4:7], s46 offen  lds
    s_add_u32 m0, m0, s54
    s_add_u32 s45, s46, s53
    buffer_load_dwordx4 v2, s[4:7], s45 offen  lds
    s_add_u32 m0, m0, s54
    s_add_u32 s46, s45, s53
    buffer_load_dwordx4 v2, s[4:7], s46 offen  lds
    s_add_u32 s41, s41, 33664
    s_cmp_ge_u32 s41, s51
    s_cselect_b32 s41, s50, s41
    s_mov_b32 m0, s43
    s_add_u32 s45, s42, s38
    buffer_load_dwordx4 v4, s[8:11], s42 offen  lds
    s_branch L_ltouch
L_lret:
    s_sub_u32 s52, s52, 1
    s_cbranch_scc0 L_lloop
    s_load_dwordx2 s[12:13], s[0:1], 48
    s_waitcnt vmcnt(13)
    s_barrier
    s_add_u32 m0, m0, s39
    s_add_u32 s46, s45, s38
    buffer_load_dwordx4 v4, s[8:11], s45 offen  lds
    s_add_u32 m0, m0, s39
    s_addk_i32 s43, 12288
    buffer_load_dwordx4 v4, s[8:11], s46 offen  lds
    s_cmp_ge_u32 s43, s49
    s_cselect_b32 s43, s51, s43
    s_lshr_b64 s[82:83], s[82:83], 4
    s_and_b32 s3, s82, 15
    s_lshl_b32 s40, s3, 7
    s_lshl_b32 s42, s3, 17
    s_or_b32 s42, s42, s85
    s_mov_b32 m0, s43
    s_add_u32 s45, s42, s38
    buffer_load_dwordx4 v4, s[8:11], s42 offen  lds
    s_add_u32 m0, m0, s39
    s_add_u32 s46, s45, s38
    buffer_load_dwordx4 v4, s[8:11], s45 offen  lds
    s_add_u32 m0, m0, s39
    s_addk_i32 s43, 12288
    buffer_load_dwordx4 v4, s[8:11], s46 offen  lds
    s_cmp_ge_u32 s43, s49
    s_cselect_b32 s43, s51, s43
    s_xor_b32 s42, s42, 0x10000
    s_add_u32 m0, s41, s86
    s_add_u32 s45, s40, s88
    buffer_load_dwordx4 v2, s[4:7], s45 offen  lds
    s_add_u32 m0, m0, s54
    s_add_u32 s46, s45, s53
    buffer_load_dwordx4 v2, s[4:7], s46 offen  lds
    s_add_u32 m0, m0, s54
    s_add_u32 s45, s46, s53
    buffer_load_dwordx4 v2, s[4:7], s45 offen  lds
    s_add_u32 m0, m0, s54
    s_add_u32 s46, s45, s53
    buffer_load_dwordx4 v2, s[4:7], s46 offen  lds
    s_add_u32 m0, s41, s44
    s_mov_b64 exec, 15
    buffer_load_dwordx4 v3, s[4:7], s40 offen  lds
    s_mov_b64 exec, -1
    s_add_u32 m0, s41, s87
    s_add_u32 s45, s40, s89
    buffer_load_dwordx4 v2, s[4:7], s45 offen  lds
    s_waitcnt vmcnt(12)
    s_barrier
    s_add_u32 m0, m0, s54
    s_add_u32 s46, s45, s53
    buffer_load_dwordx4 v2, s[4:7], s46 offen  lds
    s_add_u32 m0, m0, s54
    s_add_u32 s45, s46, s53
    buffer_load_dwordx4 v2, s[4:7], s45 offen  lds
    s_add_u32 m0, m0, s54
    s_add_u32 s46, s45, s53
    buffer_load_dwordx4 v2, s[4:7], s46 offen  lds
    s_add_u32 s41, s41, 33664
    s_cmp_ge_u32 s41, s51
    s_cselect_b32 s41, s50, s41
    s_mov_b32 m0, s43
    s_add_u32 s45, s42, s38
    buffer_load_dwordx4 v4, s[8:11], s42 offen  lds
    s_add_u32 m0, m0, s39
    s_add_u32 s46, s45, s38
    buffer_load_dwordx4 v4, s[8:11], s45 offen  lds
    s_add_u32 m0, m0, s39
    s_addk_i32 s43, 12288
    buffer_load_dwordx4 v4, s[8:11], s46 offen  lds
    s_cmp_ge_u32 s43, s49
    s_cselect_b32 s43, s51, s43
    s_lshr_b64 s[82:83], s[82:83], 4
    s_and_b32 s3, s82, 15
    s_lshl_b32 s40, s3, 7
    s_lshl_b32 s42, s3, 17
    s_or_b32 s42, s42, s85
    s_mov_b32 m0, s43
    s_add_u32 s45, s42, s38
    buffer_load_dwordx4 v4, s[8:11], s42 offen  lds
    s_add_u32 m0, m0, s39
    s_add_u32 s46, s45, s38
    buffer_load_dwordx4 v4, s[8:11], s45 offen  lds
    s_add_u32 m0, m0, s39
    s_addk_i32 s43, 12288
    buffer_load_dwordx4 v4, s[8:11], s46 offen  lds
    s_cmp_ge_u32 s43, s49
    s_cselect_b32 s43, s51, s43
    s_xor_b32 s42, s42, 0x10000
    s_add_u32 m0, s41, s86
    s_add_u32 s45, s40, s88
    buffer_load_dwordx4 v2, s[4:7], s45 offen  lds
    s_add_u32 m0, m0, s54
    s_add_u32 s46, s45, s53
    buffer_load_dwordx4 v2, s[4:7], s46 offen  lds
    s_waitcnt vmcnt(20)
    s_barrier
    s_add_u32 m0, m0, s54
    s_add_u32 s45, s46, s53
    buffer_load_dwordx4 v2, s[4:7], s45 offen  lds
    s_add_u32 m0, m0, s54
    s_add_u32 s46, s45, s53
    buffer_load_dwordx4 v2, s[4:7], s46 offen  lds
    s_add_u32 m0, s41, s44
    s_mov_b64 exec, 15
    buffer_load_dwordx4 v3, s[4:7], s40 offen  lds
    s_mov_b64 exec, -1
    s_add_u32 m0, s41, s87
    s_add_u32 s45, s40, s89
    buffer_load_dwordx4 v2, s[4:7], s45 offen  lds
    s_add_u32 m0, m0, s54
    s_add_u32 s46, s45, s53
    buffer_load_dwordx4 v2, s[4:7], s46 offen  lds
    s_add_u32 m0, m0, s54
    s_add_u32 s45, s46, s53
    buffer_load_dwordx4 v2, s[4:7], s45 offen  lds
    s_add_u32 m0, m0, s54
    s_add_u32 s46, s45, s53
    buffer_load_dwordx4 v2, s[4:7], s46 offen  lds
    s_add_u32 s41, s41, 33664
    s_cmp_ge_u32 s41, s51
    s_cselect_b32 s41, s50, s41
    s_waitcnt vmcnt(15)
    s_barrier
    s_mov_b32 m0, s43
    s_add_u32 s45, s42, s38
    buffer_load_dwordx4 v4, s[8:11], s42 offen  lds
    s_add_u32 m0, m0, s39
    s_add_u32 s46, s45, s38
    buffer_load_dwordx4 v4, s[8:11], s45 offen  lds
    s_add_u32 m0, m0, s39
    s_addk_i32 s43, 12288
    buffer_load_dwordx4 v4, s[8:11], s46 offen  lds
    s_cmp_ge_u32 s43, s49
    s_cselect_b32 s43, s51, s43
    s_lshr_b64 s[82:83], s[82:83], 4
    s_and_b32 s3, s82, 15
    s_lshl_b32 s40, s3, 7
    s_lshl_b32 s42, s3, 17
    s_or_b32 s42, s42, s85
    s_mov_b32 m0, s43
    s_add_u32 s45, s42, s38
    buffer_load_dwordx4 v4, s[8:11], s42 offen  lds
    s_add_u32 m0, m0, s39
    s_add_u32 s46, s45, s38
    buffer_load_dwordx4 v4, s[8:11], s45 offen  lds
    s_add_u32 m0, m0, s39
    s_addk_i32 s43, 12288
    buffer_load_dwordx4 v4, s[8:11], s46 offen  lds
    s_cmp_ge_u32 s43, s49
    s_cselect_b32 s43, s51, s43
    s_xor_b32 s42, s42, 0x10000
    s_add_u32 m0, s41, s86
    s_add_u32 s45, s40, s88
    buffer_load_dwordx4 v2, s[4:7], s45 offen  lds
    s_add_u32 m0, m0, s54
    s_add_u32 s46, s45, s53
    buffer_load_dwordx4 v2, s[4:7], s46 offen  lds
    s_add_u32 m0, m0, s54
    s_add_u32 s45, s46, s53
    buffer_load_dwordx4 v2, s[4:7], s45 offen  lds
    s_add_u32 m0, m0, s54
    s_add_u32 s46, s45, s53
    buffer_load_dwordx4 v2, s[4:7], s46 offen  lds
    s_waitcnt vmcnt(22)
    s_barrier
    s_add_u32 m0, s41, s44
    s_mov_b64 exec, 15
    buffer_load_dwordx4 v3, s[4:7], s40 offen  lds
    s_mov_b64 exec, -1
    s_add_u32 m0, s41, s87
    s_add_u32 s45, s40, s89
    buffer_load_dwordx4 v2, s[4:7], s45 offen  lds
    s_add_u32 m0, m0, s54
    s_add_u32 s46, s45, s53
    buffer_load_dwordx4 v2, s[4:7], s46 offen  lds
    s_add_u32 m0, m0, s54
    s_add_u32 s45, s46, s53
    buffer_load_dwordx4 v2, s[4:7], s45 offen  lds
    s_add_u32 m0, m0, s54
    s_add_u32 s46, s45, s53
    buffer_load_dwordx4 v2, s[4:7], s46 offen  lds
    s_add_u32 s41, s41, 33664
    s_cmp_ge_u32 s41, s51
    s_cselect_b32 s41, s50, s41
    s_mov_b32 m0, s43
    s_add_u32 s45, s42, s38
    buffer_load_dwordx4 v4, s[8:11], s42 offen  lds
    s_add_u32 m0, m0, s39
    s_add_u32 s46, s45, s38
    buffer_load_dwordx4 v4, s[8:11], s45 offen  lds
    s_add_u32 m0, m0, s39
    s_addk_i32 s43, 12288
    buffer_load_dwordx4 v4, s[8:11], s46 offen  lds
    s_cmp_ge_u32 s43, s49
    s_cselect_b32 s43, s51, s43
    s_lshr_b64 s[82:83], s[82:83], 4
    s_and_b32 s3, s82, 15
    s_lshl_b32 s40, s3, 7
    s_lshl_b32 s42, s3, 17
    s_or_b32 s42, s42, s85
    s_waitcnt vmcnt(15)
    s_barrier
    s_waitcnt vmcnt(0) lgkmcnt(0)
    s_barrier
L_store:
    s_mov_b32 s14, 0x800000
    s_mov_b32 s15, 0x20000
    s_and_b32 s3, s18, 1
    v_lshl_add_u32 v6, s3, 3, v5
    v_lshlrev_b32 v7, 1, v6
    v_cmp_lt_u32 vcc, 3, v6
    v_subrev_u32 v8, 7, v7
    v_subrev_u32 v9, 16, v7
    v_cndmask_b32 v7, v7, v8, vcc
    v_cmp_lt_u32 vcc, 11, v6
    s_nop 1
    v_cndmask_b32 v7, v7, v9, vcc
    s_lshr_b32 s3, s18, 1
    s_lshl_b32 s3, s3, 7
    s_add_u32 s3, s3, s16
    s_lshl_b32 s3, s3, 10
    s_add_u32 s3, s3, s17
    s_lshl_b32 s3, s3, 1
    v_and_b32 v8, 7, v0
    v_lshl_add_u32 v9, v8, 4, s3
    v_lshl_add_u32 v16, v7, 14, v9
    v_xor_b32 v8, v8, v5
    v_lshlrev_b32 v8, 4, v8
    v_lshl_add_u32 v8, v5, 7, v8
    s_add_u32 s3, s50, 67328
    v_add_u32 v17, s3, v8
    s_mov_b32 s46, 0
L_sloop:
    s_barrier
    ds_read_b128 v[28:31], v17
    v_add_u32 v17, s39, v17
    s_waitcnt lgkmcnt(0)
    buffer_store_dwordx4 v[28:31], v16, s[12:15], s46 offen sc1
    s_add_u32 s46, s46, s53
    s_bitcmp0_b32 s46, 14
    s_cbranch_scc1 L_sloop
    s_endpgm
    .p2align 12
L_page1:
L_compute:
    s_and_b32 s38, s18, 1
    s_bfe_u32 s39, s18, 0x10001
    v_and_b32 v10, 15, v0
    v_lshrrev_b32 v16, 4, v0
    v_lshlrev_b32 v17, 1, v10
    v_cmp_lt_u32 vcc, 3, v10
    v_subrev_u32 v18, 7, v17
    v_subrev_u32 v19, 16, v17
    v_cndmask_b32 v17, v17, v18, vcc
    v_cmp_lt_u32 vcc, 11, v10
    s_nop 1
    v_cndmask_b32 v17, v17, v19, vcc
    v_lshrrev_b32 v18, 2, v10
    v_lshl_add_u32 v19, v16, 3, v18
    v_lshlrev_b32 v19, 7, v19
    v_and_b32 v20, 3, v10
    v_lshl_add_u32 v19, v20, 3, v19
    v_lshrrev_b32 v18, 1, v18
    v_and_b32 v20, 1, v16
    v_lshl_or_b32 v18, v20, 1, v18
    s_lshl_b32 s45, s39, 1
    v_xor_b32 v18, s45, v18
    v_lshl_add_u32 v19, v18, 5, v19
    v_add_u32 v8, 100992, v19
    v_xor_b32 v9, 32, v8
    s_lshl_b32 s3, s38, 11
    s_add_u32 s46, s3, 33664
    s_bfe_u32 s47, s16, 0x10008
    v_lshl_or_b32 v21, s47, 2, v16
    v_add_u32 v18, 0, v17
    v_bfe_u32 v19, v18, 1, 3
    v_xor_b32 v19, v19, v21
    v_lshlrev_b32 v19, 4, v19
    v_lshl_add_u32 v19, v18, 7, v19
    v_add_u32 v2, s46, v19
    v_xor_b32 v5, 64, v2
    v_add_u32 v18, 1, v17
    v_bfe_u32 v19, v18, 1, 3
    v_xor_b32 v19, v19, v21
    v_lshlrev_b32 v19, 4, v19
    v_lshl_add_u32 v19, v18, 7, v19
    v_add_u32 v3, s46, v19
    v_xor_b32 v6, 64, v3
    v_add_u32 v18, -1, v17
    v_bfe_u32 v19, v18, 1, 3
    v_xor_b32 v19, v19, v21
    v_lshlrev_b32 v19, 4, v19
    v_lshl_add_u32 v19, v17, 7, v19
    v_add_u32 v4, s46, v19
    v_xor_b32 v7, 64, v4
    v_lshrrev_b32 v18, 1, v16
    v_lshl_add_u32 v18, s39, 2, v18
    v_and_b32 v19, 7, v10
    v_xor_b32 v18, v18, v19
    v_lshlrev_b32 v18, 4, v18
    v_lshl_add_u32 v18, v20, 3, v18
    v_lshl_add_u32 v18, v10, 7, v18
    s_add_u32 s3, s3, 67328
    v_add_u32 v1, s3, v18
    v_xor_b32 v11, 32, v1
    s_lshl_b32 s3, s39, 6
    s_add_u32 s3, s3, 162432
    v_and_b32 v18, 4, v10
    v_add_lshl_u32 v18, v18, v16, 2
    v_and_or_b32 v18, v10, 3, v18
    v_lshl_add_u32 v10, v18, 1, s3
    v_mov_b64 v[24:25], 0
    v_mov_b64 v[26:27], 0
    s_mov_b64 vcc, 0
    s_mov_b32 s40, 1
    s_mov_b32 s41, 1
    s_mov_b32 s42, 0xbfb8aa3b
    s_movk_i32 s53, 12288
    s_mov_b32 s54, 33664
    s_mov_b32 s46, 0xffff4000
    s_mov_b32 s47, 0xfffef900
    s_mov_b32 s52, 12
    s_setprio 1
    s_barrier
    ds_read_u16_d16_hi v24, v10 offset:0
    ds_read_u16_d16_hi v25, v10 offset:128
    ds_read_u16_d16_hi v26, v10 offset:256
    ds_read_u16_d16_hi v27, v10 offset:384
    s_waitcnt lgkmcnt(0)
    v_add_f32 v25, 0x3727c5ac, v25
    v_cvt_pk_bf16_f32 v25, v25, v25
    v_lshlrev_b32 v25, 16, v25
    v_sqrt_f32 v25, v25
    s_nop 0
    v_cvt_pk_bf16_f32 v25, v25, v25
    v_lshlrev_b32 v25, 16, v25
    v_rcp_f32 v25, v25
    s_nop 0
    v_cvt_pk_bf16_f32 v25, v25, v25
    v_lshlrev_b32 v25, 16, v25
    v_mul_f32 v25, v26, v25
    v_cvt_pk_bf16_f32 v25, v25, v25
    v_lshlrev_b32 v25, 16, v25
    v_rcp_f32 v26, v25
    v_mul_f32 v32, s42, v25
    v_mul_f32 v26, v27, v26
    v_max_f32_e64 v26, |v24|, |v26|
    v_mov_b32_dpp v16, v32 row_newbcast:0 row_mask:0xf bank_mask:0xf
    v_mov_b32_dpp v17, v32 row_newbcast:1 row_mask:0xf bank_mask:0xf
    v_min_u32_dpp v26, v26, v26 row_ror:1 row_mask:0xf bank_mask:0xf
    v_mov_b32_dpp v18, v32 row_newbcast:2 row_mask:0xf bank_mask:0xf
    v_mov_b32_dpp v19, v32 row_newbcast:3 row_mask:0xf bank_mask:0xf
    v_min_u32_dpp v26, v26, v26 row_ror:2 row_mask:0xf bank_mask:0xf
    v_mov_b32_dpp v20, v32 row_newbcast:4 row_mask:0xf bank_mask:0xf
    v_mov_b32_dpp v21, v32 row_newbcast:5 row_mask:0xf bank_mask:0xf
    v_min_u32_dpp v26, v26, v26 row_ror:4 row_mask:0xf bank_mask:0xf
    v_mov_b32_dpp v22, v32 row_newbcast:6 row_mask:0xf bank_mask:0xf
    v_mov_b32_dpp v23, v32 row_newbcast:7 row_mask:0xf bank_mask:0xf
    v_readlane_b32 s24, v26, 0
    v_readlane_b32 s25, v26, 16
    v_readlane_b32 s26, v26, 32
    v_readlane_b32 s27, v26, 48
    s_min_u32 s24, s24, s25
    s_min_u32 s26, s26, s27
    s_min_u32 s24, s24, s26
    s_min_u32 s24, s24, 0x70000000
    s_and_b32 s24, s24, 0x7f800000
    s_cselect_b32 s25, 0x2c00000, 0
    s_add_u32 s24, s24, s25
    v_fma_f32 v27, -v24, v25, v27
    v_fma_f32 v27, -s24, v25, v27
    v_mul_f32 v33, s42, v27
    v_mov_b32 v40, s24
    v_mov_b32 v41, s24
    v_mov_b32 v42, s24
    v_mov_b32 v43, s24
    v_mov_b32_dpp v24, v33 row_newbcast:0 row_mask:0xf bank_mask:0xf
    v_mov_b32_dpp v25, v33 row_newbcast:1 row_mask:0xf bank_mask:0xf
    v_mov_b32_dpp v26, v33 row_newbcast:2 row_mask:0xf bank_mask:0xf
    v_mov_b32_dpp v27, v33 row_newbcast:3 row_mask:0xf bank_mask:0xf
    v_mov_b32_dpp v28, v33 row_newbcast:4 row_mask:0xf bank_mask:0xf
    v_mov_b32_dpp v29, v33 row_newbcast:5 row_mask:0xf bank_mask:0xf
    v_mov_b32_dpp v30, v33 row_newbcast:6 row_mask:0xf bank_mask:0xf
    v_mov_b32_dpp v31, v33 row_newbcast:7 row_mask:0xf bank_mask:0xf
    s_barrier
    ds_read_b64_tr_b16 v[168:169], v8 offset:0
    ds_read_b64_tr_b16 v[170:171], v8 offset:512
    ds_read_b128 v[128:131], v4 offset:29440
    ds_read_b64_tr_b16 v[176:177], v8 offset:4096
    ds_read_b64_tr_b16 v[178:179], v8 offset:4608
    ds_read_b128 v[132:135], v2 offset:0
    ds_read_b64_tr_b16 v[184:185], v8 offset:8192
    ds_read_b64_tr_b16 v[186:187], v8 offset:8704
    ds_read_b128 v[136:139], v2 offset:4224
    ds_read_b128 v[140:143], v2 offset:8448
    s_waitcnt lgkmcnt(7)
    v_mfma_f32_16x16x32_bf16 v[64:67], v[168:171], v[128:131], v[40:43]
    ds_read_b128 v[144:147], v2 offset:12672
    s_waitcnt lgkmcnt(5)
    v_mfma_f32_16x16x32_bf16 v[64:67], v[176:179], v[132:135], v[64:67]
    ds_read_b128 v[148:151], v2 offset:16896
    s_waitcnt lgkmcnt(3)
    v_mfma_f32_16x16x32_bf16 v[64:67], v[184:187], v[136:139], v[64:67]
    ds_read_b128 v[152:155], v2 offset:21120
    s_waitcnt lgkmcnt(3)
    v_mfma_f32_16x16x32_bf16 v[72:75], v[184:187], v[140:143], v[40:43]
    ds_read_b128 v[156:159], v2 offset:25344
    v_mfma_f32_16x16x32_bf16 v[72:75], v[176:179], v[136:139], v[72:75]
    ds_read_b128 v[160:163], v2 offset:29568
    v_mfma_f32_16x16x32_bf16 v[72:75], v[168:171], v[132:135], v[72:75]
    ds_read_b128 v[164:167], v3 offset:0
    v_mfma_f32_16x16x32_bf16 v[80:83], v[168:171], v[136:139], v[40:43]
    ds_read_b64_tr_b16 v[172:173], v9 offset:0
    ds_read_b64_tr_b16 v[174:175], v9 offset:512
    v_mfma_f32_16x16x32_bf16 v[80:83], v[176:179], v[140:143], v[80:83]
    ds_read_b64_tr_b16 v[180:181], v9 offset:4096
    ds_read_b64_tr_b16 v[182:183], v9 offset:4608
    s_waitcnt lgkmcnt(9)
    v_mfma_f32_16x16x32_bf16 v[80:83], v[184:187], v[144:147], v[80:83]
    ds_read_b64_tr_b16 v[188:189], v9 offset:8192
    ds_read_b64_tr_b16 v[190:191], v9 offset:8704
    s_waitcnt lgkmcnt(10)
    v_mfma_f32_16x16x32_bf16 v[88:91], v[184:187], v[148:151], v[40:43]
    v_mfma_f32_16x16x32_bf16 v[88:91], v[176:179], v[144:147], v[88:91]
    v_mfma_f32_16x16x32_bf16 v[88:91], v[168:171], v[140:143], v[88:91]
    v_mfma_f32_16x16x32_bf16 v[96:99], v[168:171], v[144:147], v[40:43]
    v_mfma_f32_16x16x32_bf16 v[96:99], v[176:179], v[148:151], v[96:99]
    s_waitcnt lgkmcnt(9)
    v_mfma_f32_16x16x32_bf16 v[96:99], v[184:187], v[152:155], v[96:99]
    s_waitcnt lgkmcnt(8)
    v_mfma_f32_16x16x32_bf16 v[104:107], v[184:187], v[156:159], v[40:43]
    v_mfma_f32_16x16x32_bf16 v[104:107], v[176:179], v[152:155], v[104:107]
    v_mfma_f32_16x16x32_bf16 v[104:107], v[168:171], v[148:151], v[104:107]
    v_mfma_f32_16x16x32_bf16 v[112:115], v[168:171], v[152:155], v[40:43]
    v_mfma_f32_16x16x32_bf16 v[112:115], v[176:179], v[156:159], v[112:115]
    v_add_u32 v8, s53, v8
    v_add_u32 v9, s53, v9
    s_waitcnt lgkmcnt(7)
    v_mfma_f32_16x16x32_bf16 v[112:115], v[184:187], v[160:163], v[112:115]
    s_waitcnt lgkmcnt(0)
    s_barrier
    ds_read_b128 v[192:195], v7 offset:29440
    ds_read_b64_tr_b16 v[232:233], v8 offset:0
    v_mfma_f32_16x16x32_bf16 v[120:123], v[184:187], v[164:167], v[40:43]
    ds_read_b128 v[196:199], v5 offset:0
    v_mfma_f32_16x16x32_bf16 v[120:123], v[176:179], v[160:163], v[120:123]
    ds_read_b64_tr_b16 v[234:235], v8 offset:512
    v_mfma_f32_16x16x32_bf16 v[120:123], v[168:171], v[156:159], v[120:123]
    ds_read_b128 v[200:203], v5 offset:4224
    v_mfma_f32_16x16x32_bf16 v[124:127], v[172:175], v[156:159], v[40:43]
    ds_read_b64_tr_b16 v[240:241], v8 offset:4096
    v_mfma_f32_16x16x32_bf16 v[124:127], v[180:183], v[160:163], v[124:127]
    ds_read_b128 v[204:207], v5 offset:8448
    v_mfma_f32_16x16x32_bf16 v[124:127], v[188:191], v[164:167], v[124:127]
    ds_read_b64_tr_b16 v[242:243], v8 offset:4608
    v_mfma_f32_16x16x32_bf16 v[116:119], v[188:191], v[160:163], v[40:43]
    ds_read_b128 v[208:211], v5 offset:12672
    v_mfma_f32_16x16x32_bf16 v[116:119], v[180:183], v[156:159], v[116:119]
    ds_read_b64_tr_b16 v[248:249], v8 offset:8192
    v_mfma_f32_16x16x32_bf16 v[116:119], v[172:175], v[152:155], v[116:119]
    ds_read_b128 v[212:215], v5 offset:16896
    v_mfma_f32_16x16x32_bf16 v[108:111], v[172:175], v[148:151], v[40:43]
    ds_read_b64_tr_b16 v[250:251], v8 offset:8704
    ds_read_b128 v[216:219], v5 offset:21120
    v_mfma_f32_16x16x32_bf16 v[108:111], v[180:183], v[152:155], v[108:111]
    ds_read_b64_tr_b16 v[236:237], v9 offset:0
    v_mfma_f32_16x16x32_bf16 v[108:111], v[188:191], v[156:159], v[108:111]
    ds_read_b128 v[220:223], v5 offset:25344
    v_mfma_f32_16x16x32_bf16 v[100:103], v[188:191], v[152:155], v[40:43]
    ds_read_b64_tr_b16 v[238:239], v9 offset:512
    v_mfma_f32_16x16x32_bf16 v[100:103], v[180:183], v[148:151], v[100:103]
    ds_read_b128 v[224:227], v5 offset:29568
    v_mfma_f32_16x16x32_bf16 v[100:103], v[172:175], v[144:147], v[100:103]
    ds_read_b64_tr_b16 v[244:245], v9 offset:4096
    v_mfma_f32_16x16x32_bf16 v[92:95], v[172:175], v[140:143], v[40:43]
    ds_read_b128 v[228:231], v6 offset:0
    v_mfma_f32_16x16x32_bf16 v[92:95], v[180:183], v[144:147], v[92:95]
    ds_read_b64_tr_b16 v[246:247], v9 offset:4608
    v_mfma_f32_16x16x32_bf16 v[92:95], v[188:191], v[148:151], v[92:95]
    ds_read_b64_tr_b16 v[252:253], v9 offset:8192
    v_mfma_f32_16x16x32_bf16 v[84:87], v[188:191], v[144:147], v[40:43]
    ds_read_b64_tr_b16 v[254:255], v9 offset:8704
    v_mfma_f32_16x16x32_bf16 v[84:87], v[180:183], v[140:143], v[84:87]
    s_add_u32 s41, s41, 1
    s_cmp_eq_u32 s41, 5
    s_cselect_b32 s43, s46, s53
    s_cselect_b32 s41, 0, s41
    v_mfma_f32_16x16x32_bf16 v[84:87], v[172:175], v[136:139], v[84:87]
    v_add_u32 v8, s43, v8
    v_mfma_f32_16x16x32_bf16 v[76:79], v[172:175], v[132:135], v[40:43]
    v_add_u32 v9, s43, v9
    s_add_u32 s40, s40, 1
    s_cmp_eq_u32 s40, 3
    v_mfma_f32_16x16x32_bf16 v[76:79], v[180:183], v[136:139], v[76:79]
    s_cselect_b32 s55, s47, s54
    s_cselect_b32 s40, 0, s40
    v_mfma_f32_16x16x32_bf16 v[76:79], v[188:191], v[140:143], v[76:79]
    v_add_u32 v2, s55, v2
    v_add_u32 v3, s55, v3
    v_mfma_f32_16x16x32_bf16 v[68:71], v[188:191], v[136:139], v[40:43]
    v_add_u32 v4, s55, v4
    v_mfma_f32_16x16x32_bf16 v[68:71], v[180:183], v[132:135], v[68:71]
    v_mfma_f32_16x16x32_bf16 v[68:71], v[172:175], v[128:131], v[68:71]
    s_branch L_centry
L_touch0:
    .p2align 6
L_cloop:
    v_mfma_f32_16x16x32_bf16 v[68:71], v[188:191], v[136:139], v[68:71]
    v_mfma_f32_16x16x32_bf16 v[68:71], v[180:183], v[132:135], v[68:71]
    v_mfma_f32_16x16x32_bf16 v[68:71], v[172:175], v[128:131], v[68:71]
L_centry:
    s_waitcnt lgkmcnt(0)
    s_barrier
    v_mfma_f32_16x16x32_bf16 v[68:71], v[236:239], v[192:195], v[68:71]
    ds_read_b128 v[128:131], v4 offset:29440
    v_mfma_f32_16x16x32_bf16 v[68:71], v[244:247], v[196:199], v[68:71]
    ds_read_b64_tr_b16 v[168:169], v8 offset:0
    v_mfma_f32_16x16x32_bf16 v[68:71], v[252:255], v[200:203], v[68:71]
    v_mfma_f32_16x16x32_bf16 v[76:79], v[252:255], v[204:207], v[76:79]
    ds_read_b128 v[132:135], v2 offset:0
    v_mfma_f32_16x16x32_bf16 v[76:79], v[244:247], v[200:203], v[76:79]
    ds_read_b64_tr_b16 v[170:171], v8 offset:512
    v_mfma_f32_16x16x32_bf16 v[76:79], v[236:239], v[196:199], v[76:79]
    v_mfma_f32_16x16x32_bf16 v[84:87], v[236:239], v[200:203], v[84:87]
    ds_read_b128 v[136:139], v2 offset:4224
    v_mfma_f32_16x16x32_bf16 v[84:87], v[244:247], v[204:207], v[84:87]
    ds_read_b64_tr_b16 v[176:177], v8 offset:4096
    v_mfma_f32_16x16x32_bf16 v[84:87], v[252:255], v[208:211], v[84:87]
    v_mfma_f32_16x16x32_bf16 v[92:95], v[252:255], v[212:215], v[92:95]
    ds_read_b128 v[140:143], v2 offset:8448
    v_mfma_f32_16x16x32_bf16 v[92:95], v[244:247], v[208:211], v[92:95]
    ds_read_b64_tr_b16 v[178:179], v8 offset:4608
    v_mfma_f32_16x16x32_bf16 v[92:95], v[236:239], v[204:207], v[92:95]
    v_mfma_f32_16x16x32_bf16 v[100:103], v[236:239], v[208:211], v[100:103]
    ds_read_b128 v[144:147], v2 offset:12672
    v_mfma_f32_16x16x32_bf16 v[100:103], v[244:247], v[212:215], v[100:103]
    ds_read_b64_tr_b16 v[184:185], v8 offset:8192
    v_mfma_f32_16x16x32_bf16 v[100:103], v[252:255], v[216:219], v[100:103]
    v_mfma_f32_16x16x32_bf16 v[108:111], v[252:255], v[220:223], v[108:111]
    ds_read_b128 v[148:151], v2 offset:16896
    v_mfma_f32_16x16x32_bf16 v[108:111], v[244:247], v[216:219], v[108:111]
    ds_read_b64_tr_b16 v[186:187], v8 offset:8704
    v_mfma_f32_16x16x32_bf16 v[108:111], v[236:239], v[212:215], v[108:111]
    v_mfma_f32_16x16x32_bf16 v[116:119], v[236:239], v[216:219], v[116:119]
    ds_read_b128 v[152:155], v2 offset:21120
    v_mfma_f32_16x16x32_bf16 v[116:119], v[244:247], v[220:223], v[116:119]
    ds_read_b64_tr_b16 v[172:173], v9 offset:0
    v_mfma_f32_16x16x32_bf16 v[116:119], v[252:255], v[224:227], v[116:119]
    v_mfma_f32_16x16x32_bf16 v[124:127], v[252:255], v[228:231], v[124:127]
    ds_read_b128 v[156:159], v2 offset:25344
    v_mfma_f32_16x16x32_bf16 v[124:127], v[244:247], v[224:227], v[124:127]
    ds_read_b64_tr_b16 v[174:175], v9 offset:512
    v_mfma_f32_16x16x32_bf16 v[124:127], v[236:239], v[220:223], v[124:127]
    v_mfma_f32_16x16x32_bf16 v[120:123], v[232:235], v[220:223], v[120:123]
    ds_read_b128 v[160:163], v2 offset:29568
    v_mfma_f32_16x16x32_bf16 v[120:123], v[240:243], v[224:227], v[120:123]
    ds_read_b64_tr_b16 v[180:181], v9 offset:4096
    v_mfma_f32_16x16x32_bf16 v[120:123], v[248:251], v[228:231], v[120:123]
    v_mfma_f32_16x16x32_bf16 v[112:115], v[248:251], v[224:227], v[112:115]
    ds_read_b128 v[164:167], v3 offset:0
    v_mfma_f32_16x16x32_bf16 v[112:115], v[240:243], v[220:223], v[112:115]
    ds_read_b64_tr_b16 v[182:183], v9 offset:4608
    v_mfma_f32_16x16x32_bf16 v[112:115], v[232:235], v[216:219], v[112:115]
    v_mfma_f32_16x16x32_bf16 v[104:107], v[232:235], v[212:215], v[104:107]
    ds_read_b64_tr_b16 v[188:189], v9 offset:8192
    v_mfma_f32_16x16x32_bf16 v[104:107], v[240:243], v[216:219], v[104:107]
    ds_read_b64_tr_b16 v[190:191], v9 offset:8704
    v_mfma_f32_16x16x32_bf16 v[104:107], v[248:251], v[220:223], v[104:107]
    v_mfma_f32_16x16x32_bf16 v[96:99], v[248:251], v[216:219], v[96:99]
    s_add_u32 s41, s41, 1
    s_cmp_eq_u32 s41, 5
    v_mfma_f32_16x16x32_bf16 v[96:99], v[240:243], v[212:215], v[96:99]
    s_cselect_b32 s43, s46, s53
    s_cselect_b32 s41, 0, s41
    v_mfma_f32_16x16x32_bf16 v[96:99], v[232:235], v[208:211], v[96:99]
    v_add_u32 v8, s43, v8
    v_mfma_f32_16x16x32_bf16 v[88:91], v[232:235], v[204:207], v[88:91]
    v_add_u32 v9, s43, v9
    v_mfma_f32_16x16x32_bf16 v[88:91], v[240:243], v[208:211], v[88:91]
    v_add_u32 v5, s55, v5
    v_mfma_f32_16x16x32_bf16 v[88:91], v[248:251], v[212:215], v[88:91]
    v_add_u32 v6, s55, v6
    v_mfma_f32_16x16x32_bf16 v[80:83], v[248:251], v[208:211], v[80:83]
    v_add_u32 v7, s55, v7
    v_mfma_f32_16x16x32_bf16 v[80:83], v[240:243], v[204:207], v[80:83]
    v_mfma_f32_16x16x32_bf16 v[80:83], v[232:235], v[200:203], v[80:83]
    v_mfma_f32_16x16x32_bf16 v[72:75], v[232:235], v[196:199], v[72:75]
    v_mfma_f32_16x16x32_bf16 v[72:75], v[240:243], v[200:203], v[72:75]
    v_mfma_f32_16x16x32_bf16 v[72:75], v[248:251], v[204:207], v[72:75]
    v_mfma_f32_16x16x32_bf16 v[64:67], v[248:251], v[200:203], v[64:67]
    v_mfma_f32_16x16x32_bf16 v[64:67], v[240:243], v[196:199], v[64:67]
    v_mfma_f32_16x16x32_bf16 v[64:67], v[232:235], v[192:195], v[64:67]
    s_waitcnt lgkmcnt(0)
    s_barrier
    v_mfma_f32_16x16x32_bf16 v[64:67], v[168:171], v[128:131], v[64:67]
    ds_read_b128 v[192:195], v7 offset:29440
    v_mfma_f32_16x16x32_bf16 v[64:67], v[176:179], v[132:135], v[64:67]
    ds_read_b64_tr_b16 v[232:233], v8 offset:0
    v_mfma_f32_16x16x32_bf16 v[64:67], v[184:187], v[136:139], v[64:67]
    v_mfma_f32_16x16x32_bf16 v[72:75], v[184:187], v[140:143], v[72:75]
    ds_read_b128 v[196:199], v5 offset:0
    v_mfma_f32_16x16x32_bf16 v[72:75], v[176:179], v[136:139], v[72:75]
    ds_read_b64_tr_b16 v[234:235], v8 offset:512
    v_mfma_f32_16x16x32_bf16 v[72:75], v[168:171], v[132:135], v[72:75]
    v_mfma_f32_16x16x32_bf16 v[80:83], v[168:171], v[136:139], v[80:83]
    ds_read_b128 v[200:203], v5 offset:4224
    v_mfma_f32_16x16x32_bf16 v[80:83], v[176:179], v[140:143], v[80:83]
    ds_read_b64_tr_b16 v[240:241], v8 offset:4096
    v_mfma_f32_16x16x32_bf16 v[80:83], v[184:187], v[144:147], v[80:83]
    v_mfma_f32_16x16x32_bf16 v[88:91], v[184:187], v[148:151], v[88:91]
    ds_read_b128 v[204:207], v5 offset:8448
    v_mfma_f32_16x16x32_bf16 v[88:91], v[176:179], v[144:147], v[88:91]
    ds_read_b64_tr_b16 v[242:243], v8 offset:4608
    v_mfma_f32_16x16x32_bf16 v[88:91], v[168:171], v[140:143], v[88:91]
    v_mfma_f32_16x16x32_bf16 v[96:99], v[168:171], v[144:147], v[96:99]
    ds_read_b128 v[208:211], v5 offset:12672
    v_mfma_f32_16x16x32_bf16 v[96:99], v[176:179], v[148:151], v[96:99]
    ds_read_b64_tr_b16 v[248:249], v8 offset:8192
    v_mfma_f32_16x16x32_bf16 v[96:99], v[184:187], v[152:155], v[96:99]
    v_mfma_f32_16x16x32_bf16 v[104:107], v[184:187], v[156:159], v[104:107]
    ds_read_b128 v[212:215], v5 offset:16896
    v_mfma_f32_16x16x32_bf16 v[104:107], v[176:179], v[152:155], v[104:107]
    ds_read_b64_tr_b16 v[250:251], v8 offset:8704
    v_mfma_f32_16x16x32_bf16 v[104:107], v[168:171], v[148:151], v[104:107]
    v_mfma_f32_16x16x32_bf16 v[112:115], v[168:171], v[152:155], v[112:115]
    ds_read_b128 v[216:219], v5 offset:21120
    v_mfma_f32_16x16x32_bf16 v[112:115], v[176:179], v[156:159], v[112:115]
    ds_read_b64_tr_b16 v[236:237], v9 offset:0
    v_mfma_f32_16x16x32_bf16 v[112:115], v[184:187], v[160:163], v[112:115]
    v_mfma_f32_16x16x32_bf16 v[120:123], v[184:187], v[164:167], v[120:123]
    ds_read_b128 v[220:223], v5 offset:25344
    v_mfma_f32_16x16x32_bf16 v[120:123], v[176:179], v[160:163], v[120:123]
    ds_read_b64_tr_b16 v[238:239], v9 offset:512
    v_mfma_f32_16x16x32_bf16 v[120:123], v[168:171], v[156:159], v[120:123]
    v_mfma_f32_16x16x32_bf16 v[124:127], v[172:175], v[156:159], v[124:127]
    ds_read_b128 v[224:227], v5 offset:29568
    v_mfma_f32_16x16x32_bf16 v[124:127], v[180:183], v[160:163], v[124:127]
    ds_read_b64_tr_b16 v[244:245], v9 offset:4096
    v_mfma_f32_16x16x32_bf16 v[124:127], v[188:191], v[164:167], v[124:127]
    v_mfma_f32_16x16x32_bf16 v[116:119], v[188:191], v[160:163], v[116:119]
    ds_read_b128 v[228:231], v6 offset:0
    v_mfma_f32_16x16x32_bf16 v[116:119], v[180:183], v[156:159], v[116:119]
    ds_read_b64_tr_b16 v[246:247], v9 offset:4608
    v_mfma_f32_16x16x32_bf16 v[116:119], v[172:175], v[152:155], v[116:119]
    v_mfma_f32_16x16x32_bf16 v[108:111], v[172:175], v[148:151], v[108:111]
    ds_read_b64_tr_b16 v[252:253], v9 offset:8192
    v_mfma_f32_16x16x32_bf16 v[108:111], v[180:183], v[152:155], v[108:111]
    ds_read_b64_tr_b16 v[254:255], v9 offset:8704
    v_mfma_f32_16x16x32_bf16 v[108:111], v[188:191], v[156:159], v[108:111]
    v_mfma_f32_16x16x32_bf16 v[100:103], v[188:191], v[152:155], v[100:103]
    s_add_u32 s41, s41, 1
    s_cmp_eq_u32 s41, 5
    v_mfma_f32_16x16x32_bf16 v[100:103], v[180:183], v[148:151], v[100:103]
    s_cselect_b32 s43, s46, s53
    s_cselect_b32 s41, 0, s41
    v_mfma_f32_16x16x32_bf16 v[100:103], v[172:175], v[144:147], v[100:103]
    v_add_u32 v8, s43, v8
    v_mfma_f32_16x16x32_bf16 v[92:95], v[172:175], v[140:143], v[92:95]
    v_add_u32 v9, s43, v9
    v_mfma_f32_16x16x32_bf16 v[92:95], v[180:183], v[144:147], v[92:95]
    s_add_u32 s40, s40, 1
    s_cmp_eq_u32 s40, 3
    v_mfma_f32_16x16x32_bf16 v[92:95], v[188:191], v[148:151], v[92:95]
    s_cselect_b32 s55, s47, s54
    s_cselect_b32 s40, 0, s40
    v_mfma_f32_16x16x32_bf16 v[84:87], v[188:191], v[144:147], v[84:87]
    v_add_u32 v2, s55, v2
    v_mfma_f32_16x16x32_bf16 v[84:87], v[180:183], v[140:143], v[84:87]
    v_add_u32 v3, s55, v3
    v_mfma_f32_16x16x32_bf16 v[84:87], v[172:175], v[136:139], v[84:87]
    v_add_u32 v4, s55, v4
    v_mfma_f32_16x16x32_bf16 v[76:79], v[172:175], v[132:135], v[76:79]
    s_sub_u32 s52, s52, 1
    v_mfma_f32_16x16x32_bf16 v[76:79], v[180:183], v[136:139], v[76:79]
    v_mfma_f32_16x16x32_bf16 v[76:79], v[188:191], v[140:143], v[76:79]
    s_cbranch_scc0 L_cloop
    v_mfma_f32_16x16x32_bf16 v[68:71], v[188:191], v[136:139], v[68:71]
    v_mfma_f32_16x16x32_bf16 v[68:71], v[180:183], v[132:135], v[68:71]
    v_mfma_f32_16x16x32_bf16 v[68:71], v[172:175], v[128:131], v[68:71]
L_tail:
    s_waitcnt lgkmcnt(0)
    s_barrier
    v_mfma_f32_16x16x32_bf16 v[68:71], v[236:239], v[192:195], v[68:71]
    v_subrev_u32 v8, 36864, v8
    s_mov_b32 s43, s42
    v_mfma_f32_16x16x32_bf16 v[68:71], v[244:247], v[196:199], v[68:71]
    v_subrev_u32 v9, 36864, v9
    ds_read_b64_tr_b16 v[128:129], v8 offset:36864
    v_mfma_f32_16x16x32_bf16 v[68:71], v[252:255], v[200:203], v[68:71]
    v_add_u32 v5, s55, v5
    ds_read_b64_tr_b16 v[130:131], v8 offset:37376
    v_mfma_f32_16x16x32_bf16 v[64:67], v[248:251], v[200:203], v[64:67]
    v_add_u32 v6, s55, v6
    ds_read_b128 v[132:135], v4 offset:29440
    v_mfma_f32_16x16x32_bf16 v[64:67], v[240:243], v[196:199], v[64:67]
    v_add_u32 v7, s55, v7
    ds_read_b64_tr_b16 v[136:137], v8 offset:40960
    v_mfma_f32_16x16x32_bf16 v[64:67], v[232:235], v[192:195], v[64:67]
    ds_read_b64_tr_b16 v[138:139], v8 offset:41472
    v_mfma_f32_16x16x32_bf16 v[72:75], v[232:235], v[196:199], v[72:75]
    ds_read_b128 v[140:143], v2 offset:0
    v_mfma_f32_16x16x32_bf16 v[72:75], v[240:243], v[200:203], v[72:75]
    ds_read_b64_tr_b16 v[144:145], v8 offset:45056
    v_mfma_f32_16x16x32_bf16 v[72:75], v[248:251], v[204:207], v[72:75]
    ds_read_b64_tr_b16 v[146:147], v8 offset:45568
    v_mfma_f32_16x16x32_bf16 v[76:79], v[252:255], v[204:207], v[76:79]
    ds_read_b128 v[148:151], v2 offset:4224
    v_mfma_f32_16x16x32_bf16 v[76:79], v[244:247], v[200:203], v[76:79]
    ds_read_b64_tr_b16 v[152:153], v8 offset:49152
    v_mfma_f32_16x16x32_bf16 v[76:79], v[236:239], v[196:199], v[76:79]
    ds_read_b64_tr_b16 v[154:155], v8 offset:49664
    v_mfma_f32_16x16x32_bf16 v[84:87], v[236:239], v[200:203], v[84:87]
    ds_read_b128 v[156:159], v7 offset:29440
    v_mfma_f32_16x16x32_bf16 v[84:87], v[244:247], v[204:207], v[84:87]
    ds_read_b64_tr_b16 v[160:161], v8 offset:53248
    v_mfma_f32_16x16x32_bf16 v[84:87], v[252:255], v[208:211], v[84:87]
    ds_read_b64_tr_b16 v[162:163], v8 offset:53760
    v_mfma_f32_16x16x32_bf16 v[80:83], v[248:251], v[208:211], v[80:83]
    ds_read_b128 v[164:167], v5 offset:0
    v_mfma_f32_16x16x32_bf16 v[80:83], v[240:243], v[204:207], v[80:83]
    ds_read_b64_tr_b16 v[168:169], v8 offset:57344
    v_mfma_f32_16x16x32_bf16 v[80:83], v[232:235], v[200:203], v[80:83]
    ds_read_b64_tr_b16 v[170:171], v8 offset:57856
    v_mfma_f32_16x16x32_bf16 v[88:91], v[232:235], v[204:207], v[88:91]
    ds_read_b128 v[172:175], v5 offset:4224
    v_mfma_f32_16x16x32_bf16 v[88:91], v[240:243], v[208:211], v[88:91]
    ds_read_b64_tr_b16 v[176:177], v9 offset:36864
    v_mfma_f32_16x16x32_bf16 v[88:91], v[248:251], v[212:215], v[88:91]
    ds_read_b64_tr_b16 v[178:179], v9 offset:37376
    v_mfma_f32_16x16x32_bf16 v[92:95], v[252:255], v[212:215], v[92:95]
    ds_read_b64_tr_b16 v[180:181], v9 offset:40960
    v_mfma_f32_16x16x32_bf16 v[92:95], v[244:247], v[208:211], v[92:95]
    ds_read_b64_tr_b16 v[182:183], v9 offset:41472
    v_mfma_f32_16x16x32_bf16 v[92:95], v[236:239], v[204:207], v[92:95]
    ds_read_b64_tr_b16 v[184:185], v9 offset:45056
    v_mfma_f32_16x16x32_bf16 v[100:103], v[236:239], v[208:211], v[100:103]
    ds_read_b64_tr_b16 v[186:187], v9 offset:45568
    v_mfma_f32_16x16x32_bf16 v[100:103], v[244:247], v[212:215], v[100:103]
    ds_read_b64_tr_b16 v[188:189], v9 offset:49152
    v_mfma_f32_16x16x32_bf16 v[100:103], v[252:255], v[216:219], v[100:103]
    ds_read_b64_tr_b16 v[190:191], v9 offset:49664
    v_mfma_f32_16x16x32_bf16 v[96:99], v[248:251], v[216:219], v[96:99]
    ds_read_b64_tr_b16 v[40:41], v9 offset:53248
    v_mfma_f32_16x16x32_bf16 v[96:99], v[240:243], v[212:215], v[96:99]
    ds_read_b64_tr_b16 v[42:43], v9 offset:53760
    v_mfma_f32_16x16x32_bf16 v[96:99], v[232:235], v[208:211], v[96:99]
    ds_read_b64_tr_b16 v[44:45], v9 offset:57344
    v_mfma_f32_16x16x32_bf16 v[104:107], v[232:235], v[212:215], v[104:107]
    ds_read_b64_tr_b16 v[46:47], v9 offset:57856
    v_mfma_f32_16x16x32_bf16 v[104:107], v[240:243], v[216:219], v[104:107]
    v_mfma_f32_16x16x32_bf16 v[104:107], v[248:251], v[220:223], v[104:107]
    v_mfma_f32_16x16x32_bf16 v[108:111], v[252:255], v[220:223], v[108:111]
    v_mfma_f32_16x16x32_bf16 v[108:111], v[244:247], v[216:219], v[108:111]
    s_barrier
    v_mfma_f32_16x16x32_bf16 v[108:111], v[236:239], v[212:215], v[108:111]
    ds_read_b64_tr_b16 v[48:49], v8 offset:0
    v_mfma_f32_16x16x32_bf16 v[116:119], v[236:239], v[216:219], v[116:119]
    ds_read_b64_tr_b16 v[50:51], v8 offset:512
    v_mfma_f32_16x16x32_bf16 v[116:119], v[244:247], v[220:223], v[116:119]
    ds_read_b128 v[52:55], v4 offset:63104
    v_mfma_f32_16x16x32_bf16 v[116:119], v[252:255], v[224:227], v[116:119]
    ds_read_b64_tr_b16 v[56:57], v8 offset:4096
    v_mfma_f32_16x16x32_bf16 v[112:115], v[248:251], v[224:227], v[112:115]
    ds_read_b64_tr_b16 v[58:59], v8 offset:4608
    v_mfma_f32_16x16x32_bf16 v[112:115], v[240:243], v[220:223], v[112:115]
    ds_read_b128 v[60:63], v2 offset:33664
    v_mfma_f32_16x16x32_bf16 v[112:115], v[232:235], v[216:219], v[112:115]
    ds_read_b64_tr_b16 v[12:13], v8 offset:8192
    v_mfma_f32_16x16x32_bf16 v[120:123], v[232:235], v[220:223], v[120:123]
    ds_read_b64_tr_b16 v[14:15], v8 offset:8704
    v_mfma_f32_16x16x32_bf16 v[120:123], v[240:243], v[224:227], v[120:123]
    ds_read_b128 v[192:195], v2 offset:37888
    v_mfma_f32_16x16x32_bf16 v[120:123], v[248:251], v[228:231], v[120:123]
    ds_read_b64_tr_b16 v[196:197], v8 offset:12288
    v_mfma_f32_16x16x32_bf16 v[124:127], v[252:255], v[228:231], v[124:127]
    ds_read_b64_tr_b16 v[198:199], v8 offset:12800
    v_mfma_f32_16x16x32_bf16 v[124:127], v[244:247], v[224:227], v[124:127]
    ds_read_b128 v[200:203], v7 offset:63104
    v_mfma_f32_16x16x32_bf16 v[124:127], v[236:239], v[220:223], v[124:127]
    ds_read_b64_tr_b16 v[204:205], v8 offset:16384
    s_waitcnt lgkmcnt(14)
    v_mfma_f32_16x16x32_bf16 v[64:67], v[128:131], v[132:135], v[64:67]
    ds_read_b64_tr_b16 v[206:207], v8 offset:16896
    v_mfma_f32_16x16x32_bf16 v[64:67], v[136:139], v[140:143], v[64:67]
    ds_read_b128 v[208:211], v5 offset:33664
    v_mfma_f32_16x16x32_bf16 v[64:67], v[144:147], v[148:151], v[64:67]
    ds_read_b64_tr_b16 v[212:213], v8 offset:20480
    v_mfma_f32_16x16x32_bf16 v[64:67], v[152:155], v[156:159], v[64:67]
    ds_read_b64_tr_b16 v[214:215], v8 offset:20992
    v_mfma_f32_16x16x32_bf16 v[64:67], v[160:163], v[164:167], v[64:67]
    ds_read_b128 v[216:219], v5 offset:37888
    v_mfma_f32_16x16x32_bf16 v[64:67], v[168:171], v[172:175], v[64:67]
    ds_read_b64_tr_b16 v[232:233], v9 offset:0
    v_mfma_f32_16x16x32_bf16 v[68:71], v[176:179], v[132:135], v[68:71]
    ds_read_b64_tr_b16 v[234:235], v9 offset:512
    v_mfma_f32_16x16x32_bf16 v[68:71], v[180:183], v[140:143], v[68:71]
    ds_read_b64_tr_b16 v[240:241], v9 offset:4096
    v_mfma_f32_16x16x32_bf16 v[68:71], v[184:187], v[148:151], v[68:71]
    ds_read_b64_tr_b16 v[242:243], v9 offset:4608
    v_mfma_f32_16x16x32_bf16 v[68:71], v[188:191], v[156:159], v[68:71]
    ds_read_b64_tr_b16 v[248:249], v9 offset:8192
    v_mfma_f32_16x16x32_bf16 v[68:71], v[40:43], v[164:167], v[68:71]
    ds_read_b64_tr_b16 v[250:251], v9 offset:8704
    s_waitcnt lgkmcnt(14)
    v_mfma_f32_16x16x32_bf16 v[68:71], v[44:47], v[172:175], v[68:71]
    ds_read_b64_tr_b16 v[252:253], v9 offset:12288
    v_mfma_f32_16x16x32_bf16 v[64:67], v[48:51], v[52:55], v[64:67]
    ds_read_b64_tr_b16 v[254:255], v9 offset:12800
    v_mfma_f32_16x16x32_bf16 v[64:67], v[56:59], v[60:63], v[64:67]
    ds_read_b64_tr_b16 v[228:229], v9 offset:16384
    v_mfma_f32_16x16x32_bf16 v[64:67], v[12:15], v[192:195], v[64:67]
    ds_read_b64_tr_b16 v[230:231], v9 offset:16896
    s_waitcnt lgkmcnt(14)
    v_mfma_f32_16x16x32_bf16 v[64:67], v[196:199], v[200:203], v[64:67]
    ds_read_b64_tr_b16 v[244:245], v9 offset:20480
    s_waitcnt lgkmcnt(14)
    v_mfma_f32_16x16x32_bf16 v[64:67], v[204:207], v[208:211], v[64:67]
    ds_read_b64_tr_b16 v[246:247], v9 offset:20992
    s_waitcnt lgkmcnt(12)
    v_mfma_f32_16x16x32_bf16 v[64:67], v[212:215], v[216:219], v[64:67]
    ds_read_b128 v[224:227], v2 offset:8448
    s_waitcnt lgkmcnt(11)
    v_mfma_f32_16x16x32_bf16 v[68:71], v[232:235], v[52:55], v[68:71]
    ds_read_b128 v[236:239], v5 offset:8448
    s_waitcnt lgkmcnt(10)
    v_mfma_f32_16x16x32_bf16 v[68:71], v[240:243], v[60:63], v[68:71]
    ds_read_b128 v[220:223], v2 offset:42112
    s_waitcnt lgkmcnt(9)
    v_mfma_f32_16x16x32_bf16 v[68:71], v[248:251], v[192:195], v[68:71]
    ds_read_b128 v[132:135], v5 offset:42112
    v_fma_f32 v64, v64, v16, v24
    v_fma_f32 v65, v65, v17, v25
    s_waitcnt lgkmcnt(8)
    v_mfma_f32_16x16x32_bf16 v[68:71], v[252:255], v[200:203], v[68:71]
    ds_read_b128 v[156:159], v2 offset:12672
L_ltouch:
    s_cbranch_vccnz L_lret
L_touch1:
    s_cbranch_scc0 L_compute
    v_fma_f32 v66, v66, v18, v26
    v_fma_f32 v67, v67, v19, v27
    s_waitcnt lgkmcnt(7)
    v_mfma_f32_16x16x32_bf16 v[68:71], v[228:231], v[208:211], v[68:71]
    ds_read_b128 v[52:55], v5 offset:12672
    v_exp_f32 v32, v64
    s_waitcnt lgkmcnt(6)
    v_mfma_f32_16x16x32_bf16 v[68:71], v[244:247], v[216:219], v[68:71]
    ds_read_b128 v[200:203], v2 offset:46336
    v_exp_f32 v33, v65
    v_mfma_f32_16x16x32_bf16 v[72:75], v[128:131], v[140:143], v[72:75]
    v_exp_f32 v34, v66
    v_exp_f32 v35, v67
    v_mfma_f32_16x16x32_bf16 v[72:75], v[136:139], v[148:151], v[72:75]
    v_fma_f32 v32, v32, s42, s42
    v_fma_f32 v33, v33, s42, s42
    s_waitcnt lgkmcnt(6)
    v_mfma_f32_16x16x32_bf16 v[72:75], v[144:147], v[224:227], v[72:75]
    v_fma_f32 v34, v34, s42, s42
    v_fma_f32 v35, v35, s42, s42
    v_rcp_f32 v32, v32
    v_mfma_f32_16x16x32_bf16 v[72:75], v[152:155], v[164:167], v[72:75]
    v_rcp_f32 v33, v33
    v_mfma_f32_16x16x32_bf16 v[72:75], v[160:163], v[172:175], v[72:75]
    v_rcp_f32 v34, v34
    v_rcp_f32 v35, v35
    s_waitcnt lgkmcnt(5)
    v_mfma_f32_16x16x32_bf16 v[72:75], v[168:171], v[236:239], v[72:75]
    v_mul_f32 v32, v32, v64
    v_mul_f32 v33, v33, v65
    v_mfma_f32_16x16x32_bf16 v[72:75], v[48:51], v[60:63], v[72:75]
    v_mul_f32 v34, v34, v66
    v_mul_f32 v35, v35, v67
    v_cvt_pk_bf16_f32 v64, v32, v33
    v_mfma_f32_16x16x32_bf16 v[72:75], v[56:59], v[192:195], v[72:75]
    v_cvt_pk_bf16_f32 v65, v34, v35
    v_fma_f32 v68, v68, v20, v28
    v_fma_f32 v69, v69, v21, v29
    s_waitcnt lgkmcnt(4)
    v_mfma_f32_16x16x32_bf16 v[72:75], v[12:15], v[220:223], v[72:75]
    v_fma_f32 v70, v70, v22, v30
    v_fma_f32 v71, v71, v23, v31
    v_exp_f32 v36, v68
    v_mfma_f32_16x16x32_bf16 v[72:75], v[196:199], v[208:211], v[72:75]
    v_exp_f32 v37, v69
    v_mfma_f32_16x16x32_bf16 v[72:75], v[204:207], v[216:219], v[72:75]
    v_exp_f32 v38, v70
    v_exp_f32 v39, v71
    s_waitcnt lgkmcnt(3)
    v_mfma_f32_16x16x32_bf16 v[72:75], v[212:215], v[132:135], v[72:75]
    v_fma_f32 v36, v36, s42, s42
    v_fma_f32 v37, v37, s42, s42
    v_mfma_f32_16x16x32_bf16 v[76:79], v[176:179], v[140:143], v[76:79]
    ds_read_b128 v[140:143], v5 offset:46336
    v_fma_f32 v38, v38, s42, s42
    v_fma_f32 v39, v39, s42, s42
    v_mfma_f32_16x16x32_bf16 v[76:79], v[180:183], v[148:151], v[76:79]
    v_rcp_f32 v36, v36
    v_rcp_f32 v37, v37
    v_mfma_f32_16x16x32_bf16 v[76:79], v[184:187], v[224:227], v[76:79]
    v_rcp_f32 v38, v38
    v_mfma_f32_16x16x32_bf16 v[76:79], v[188:191], v[164:167], v[76:79]
    ds_read_b128 v[164:167], v2 offset:16896
    v_rcp_f32 v39, v39
    v_mfma_f32_16x16x32_bf16 v[76:79], v[40:43], v[172:175], v[76:79]
    v_mul_f32 v36, v36, v68
    v_mul_f32 v37, v37, v69
    v_mul_f32 v38, v38, v70
    v_mfma_f32_16x16x32_bf16 v[76:79], v[44:47], v[236:239], v[76:79]
    v_mul_f32 v39, v39, v71
    ds_write_b64 v1, v[64:65] offset:0
    v_mfma_f32_16x16x32_bf16 v[76:79], v[232:235], v[60:63], v[76:79]
    v_cvt_pk_bf16_f32 v68, v36, v37
    v_cvt_pk_bf16_f32 v69, v38, v39
    v_mfma_f32_16x16x32_bf16 v[76:79], v[240:243], v[192:195], v[76:79]
    ds_write_b64 v11, v[68:69] offset:0
    v_mfma_f32_16x16x32_bf16 v[76:79], v[248:251], v[220:223], v[76:79]
    v_fma_f32 v72, v72, v16, v24
    v_fma_f32 v73, v73, v17, v25
    v_fma_f32 v74, v74, v18, v26
    v_mfma_f32_16x16x32_bf16 v[76:79], v[252:255], v[208:211], v[76:79]
    ds_read_b128 v[60:63], v5 offset:16896
    v_fma_f32 v75, v75, v19, v27
    v_exp_f32 v32, v72
    v_mfma_f32_16x16x32_bf16 v[76:79], v[228:231], v[216:219], v[76:79]
    ds_read_b128 v[64:67], v2 offset:50560
    v_exp_f32 v33, v73
    v_mfma_f32_16x16x32_bf16 v[76:79], v[244:247], v[132:135], v[76:79]
    ds_read_b128 v[68:71], v5 offset:50560
    v_exp_f32 v34, v74
    v_mfma_f32_16x16x32_bf16 v[80:83], v[128:131], v[148:151], v[80:83]
    ds_read_b128 v[208:211], v2 offset:21120
    v_exp_f32 v35, v75
    v_mfma_f32_16x16x32_bf16 v[80:83], v[136:139], v[224:227], v[80:83]
    v_fma_f32 v32, v32, s42, s42
    v_fma_f32 v33, v33, s42, s42
    s_waitcnt lgkmcnt(10)
    v_mfma_f32_16x16x32_bf16 v[80:83], v[144:147], v[156:159], v[80:83]
    s_waitcnt lgkmcnt(4)
    s_barrier
    v_fma_f32 v34, v34, s42, s42
    v_fma_f32 v35, v35, s42, s42
    v_rcp_f32 v32, v32
    v_mfma_f32_16x16x32_bf16 v[80:83], v[152:155], v[172:175], v[80:83]
    v_rcp_f32 v33, v33
    v_mfma_f32_16x16x32_bf16 v[80:83], v[160:163], v[236:239], v[80:83]
    v_rcp_f32 v34, v34
    v_rcp_f32 v35, v35
    v_mfma_f32_16x16x32_bf16 v[80:83], v[168:171], v[52:55], v[80:83]
    v_mul_f32 v32, v32, v72
    v_mul_f32 v33, v33, v73
    v_mfma_f32_16x16x32_bf16 v[80:83], v[48:51], v[192:195], v[80:83]
    v_mul_f32 v34, v34, v74
    v_mul_f32 v35, v35, v75
    v_cvt_pk_bf16_f32 v72, v32, v33
    v_mfma_f32_16x16x32_bf16 v[80:83], v[56:59], v[220:223], v[80:83]
    v_cvt_pk_bf16_f32 v73, v34, v35
    v_fma_f32 v76, v76, v20, v28
    v_fma_f32 v77, v77, v21, v29
    v_mfma_f32_16x16x32_bf16 v[80:83], v[12:15], v[200:203], v[80:83]
    v_fma_f32 v78, v78, v22, v30
    v_fma_f32 v79, v79, v23, v31
    v_exp_f32 v36, v76
    v_mfma_f32_16x16x32_bf16 v[80:83], v[196:199], v[216:219], v[80:83]
    v_exp_f32 v37, v77
    v_mfma_f32_16x16x32_bf16 v[80:83], v[204:207], v[132:135], v[80:83]
    v_exp_f32 v38, v78
    v_exp_f32 v39, v79
    v_mfma_f32_16x16x32_bf16 v[80:83], v[212:215], v[140:143], v[80:83]
    v_fma_f32 v36, v36, s42, s42
    v_fma_f32 v37, v37, s42, s42
    v_mfma_f32_16x16x32_bf16 v[84:87], v[176:179], v[148:151], v[84:87]
    ds_read_b128 v[148:151], v5 offset:21120
    v_fma_f32 v38, v38, s42, s42
    v_fma_f32 v39, v39, s42, s42
    v_mfma_f32_16x16x32_bf16 v[84:87], v[180:183], v[224:227], v[84:87]
    v_rcp_f32 v36, v36
    v_rcp_f32 v37, v37
    v_mfma_f32_16x16x32_bf16 v[84:87], v[184:187], v[156:159], v[84:87]
    v_rcp_f32 v38, v38
    v_mfma_f32_16x16x32_bf16 v[84:87], v[188:191], v[172:175], v[84:87]
    ds_read_b128 v[172:175], v2 offset:54784
    v_rcp_f32 v39, v39
    v_mfma_f32_16x16x32_bf16 v[84:87], v[40:43], v[236:239], v[84:87]
    v_mul_f32 v36, v36, v76
    v_mul_f32 v37, v37, v77
    v_mul_f32 v38, v38, v78
    v_mfma_f32_16x16x32_bf16 v[84:87], v[44:47], v[52:55], v[84:87]
    v_mul_f32 v39, v39, v79
    ds_write_b64 v1, v[72:73] offset:4096
    v_mfma_f32_16x16x32_bf16 v[84:87], v[232:235], v[192:195], v[84:87]
    v_cvt_pk_bf16_f32 v76, v36, v37
    v_cvt_pk_bf16_f32 v77, v38, v39
    v_mfma_f32_16x16x32_bf16 v[84:87], v[240:243], v[220:223], v[84:87]
    ds_write_b64 v11, v[76:77] offset:4096
    v_mfma_f32_16x16x32_bf16 v[84:87], v[248:251], v[200:203], v[84:87]
    v_fma_f32 v80, v80, v16, v24
    v_fma_f32 v81, v81, v17, v25
    v_fma_f32 v82, v82, v18, v26
    v_mfma_f32_16x16x32_bf16 v[84:87], v[252:255], v[216:219], v[84:87]
    ds_read_b128 v[192:195], v5 offset:54784
    v_fma_f32 v83, v83, v19, v27
    v_exp_f32 v32, v80
    v_mfma_f32_16x16x32_bf16 v[84:87], v[228:231], v[132:135], v[84:87]
    ds_read_b128 v[72:75], v2 offset:25344
    v_exp_f32 v33, v81
    v_mfma_f32_16x16x32_bf16 v[84:87], v[244:247], v[140:143], v[84:87]
    ds_read_b128 v[76:79], v5 offset:25344
    v_exp_f32 v34, v82
    v_mfma_f32_16x16x32_bf16 v[88:91], v[128:131], v[224:227], v[88:91]
    ds_read_b128 v[216:219], v2 offset:59008
    v_exp_f32 v35, v83
    v_mfma_f32_16x16x32_bf16 v[88:91], v[136:139], v[156:159], v[88:91]
    v_fma_f32 v32, v32, s42, s42
    v_fma_f32 v33, v33, s42, s42
    v_mfma_f32_16x16x32_bf16 v[88:91], v[144:147], v[164:167], v[88:91]
    s_waitcnt lgkmcnt(4)
    s_barrier
    v_fma_f32 v34, v34, s42, s42
    v_fma_f32 v35, v35, s42, s42
    v_rcp_f32 v32, v32
    v_mfma_f32_16x16x32_bf16 v[88:91], v[152:155], v[236:239], v[88:91]
    v_rcp_f32 v33, v33
    v_mfma_f32_16x16x32_bf16 v[88:91], v[160:163], v[52:55], v[88:91]
    v_rcp_f32 v34, v34
    v_rcp_f32 v35, v35
    v_mfma_f32_16x16x32_bf16 v[88:91], v[168:171], v[60:63], v[88:91]
    v_mul_f32 v32, v32, v80
    v_mul_f32 v33, v33, v81
    v_mfma_f32_16x16x32_bf16 v[88:91], v[48:51], v[220:223], v[88:91]
    v_mul_f32 v34, v34, v82
    v_mul_f32 v35, v35, v83
    v_cvt_pk_bf16_f32 v80, v32, v33
    v_mfma_f32_16x16x32_bf16 v[88:91], v[56:59], v[200:203], v[88:91]
    v_cvt_pk_bf16_f32 v81, v34, v35
L_touch2:
    s_cbranch_scc0 L_compute
    v_fma_f32 v84, v84, v20, v28
    v_fma_f32 v85, v85, v21, v29
    v_mfma_f32_16x16x32_bf16 v[88:91], v[12:15], v[64:67], v[88:91]
    v_fma_f32 v86, v86, v22, v30
    v_fma_f32 v87, v87, v23, v31
    v_exp_f32 v36, v84
    v_mfma_f32_16x16x32_bf16 v[88:91], v[196:199], v[132:135], v[88:91]
    v_exp_f32 v37, v85
    v_mfma_f32_16x16x32_bf16 v[88:91], v[204:207], v[140:143], v[88:91]
    v_exp_f32 v38, v86
    v_exp_f32 v39, v87
    v_mfma_f32_16x16x32_bf16 v[88:91], v[212:215], v[68:71], v[88:91]
    v_fma_f32 v36, v36, s42, s42
    v_fma_f32 v37, v37, s42, s42
    v_mfma_f32_16x16x32_bf16 v[92:95], v[176:179], v[224:227], v[92:95]
    ds_read_b128 v[224:227], v5 offset:59008
    v_fma_f32 v38, v38, s42, s42
    v_fma_f32 v39, v39, s42, s42
    v_mfma_f32_16x16x32_bf16 v[92:95], v[180:183], v[156:159], v[92:95]
    v_rcp_f32 v36, v36
    v_rcp_f32 v37, v37
    v_mfma_f32_16x16x32_bf16 v[92:95], v[184:187], v[164:167], v[92:95]
    v_rcp_f32 v38, v38
    v_mfma_f32_16x16x32_bf16 v[92:95], v[188:191], v[236:239], v[92:95]
    ds_read_b128 v[236:239], v2 offset:29568
    v_rcp_f32 v39, v39
    v_mfma_f32_16x16x32_bf16 v[92:95], v[40:43], v[52:55], v[92:95]
    v_mul_f32 v36, v36, v84
    v_mul_f32 v37, v37, v85
    v_mfma_f32_16x16x32_bf16 v[92:95], v[44:47], v[60:63], v[92:95]
    v_mul_f32 v38, v38, v86
    v_mul_f32 v39, v39, v87
    ds_write_b64 v1, v[80:81] offset:8192
    v_mfma_f32_16x16x32_bf16 v[92:95], v[232:235], v[220:223], v[92:95]
    v_cvt_pk_bf16_f32 v84, v36, v37
    v_mfma_f32_16x16x32_bf16 v[92:95], v[240:243], v[200:203], v[92:95]
    v_cvt_pk_bf16_f32 v85, v38, v39
    ds_write_b64 v11, v[84:85] offset:8192
    v_mfma_f32_16x16x32_bf16 v[92:95], v[248:251], v[64:67], v[92:95]
    v_fma_f32 v88, v88, v16, v24
    v_fma_f32 v89, v89, v17, v25
    v_mfma_f32_16x16x32_bf16 v[92:95], v[252:255], v[132:135], v[92:95]
    ds_read_b128 v[220:223], v5 offset:29568
    v_fma_f32 v90, v90, v18, v26
    v_fma_f32 v91, v91, v19, v27
    v_mfma_f32_16x16x32_bf16 v[92:95], v[228:231], v[140:143], v[92:95]
    ds_read_b128 v[80:83], v2 offset:63232
    v_exp_f32 v32, v88
    v_mfma_f32_16x16x32_bf16 v[92:95], v[244:247], v[68:71], v[92:95]
    ds_read_b128 v[84:87], v5 offset:63232
    v_exp_f32 v33, v89
    v_mfma_f32_16x16x32_bf16 v[96:99], v[128:131], v[156:159], v[96:99]
    ds_read_b128 v[132:135], v3 offset:0
    v_exp_f32 v34, v90
    v_mfma_f32_16x16x32_bf16 v[96:99], v[136:139], v[164:167], v[96:99]
    v_exp_f32 v35, v91
    v_fma_f32 v32, v32, s42, s42
    v_mfma_f32_16x16x32_bf16 v[96:99], v[144:147], v[208:211], v[96:99]
    s_waitcnt lgkmcnt(4)
    s_barrier
    v_fma_f32 v33, v33, s42, s42
    v_fma_f32 v34, v34, s42, s42
    v_fma_f32 v35, v35, s42, s42
    v_mfma_f32_16x16x32_bf16 v[96:99], v[152:155], v[52:55], v[96:99]
    v_rcp_f32 v32, v32
    v_rcp_f32 v33, v33
    v_mfma_f32_16x16x32_bf16 v[96:99], v[160:163], v[60:63], v[96:99]
    v_rcp_f32 v34, v34
    v_mfma_f32_16x16x32_bf16 v[96:99], v[168:171], v[148:151], v[96:99]
    v_rcp_f32 v35, v35
    v_mul_f32 v32, v32, v88
    v_mfma_f32_16x16x32_bf16 v[96:99], v[48:51], v[200:203], v[96:99]
    v_mul_f32 v33, v33, v89
    v_mul_f32 v34, v34, v90
    v_mul_f32 v35, v35, v91
    v_mfma_f32_16x16x32_bf16 v[96:99], v[56:59], v[64:67], v[96:99]
    v_cvt_pk_bf16_f32 v88, v32, v33
    v_cvt_pk_bf16_f32 v89, v34, v35
    v_fma_f32 v92, v92, v20, v28
    v_mfma_f32_16x16x32_bf16 v[96:99], v[12:15], v[172:175], v[96:99]
    v_fma_f32 v93, v93, v21, v29
    v_fma_f32 v94, v94, v22, v30
    v_fma_f32 v95, v95, v23, v31
    v_mfma_f32_16x16x32_bf16 v[96:99], v[196:199], v[140:143], v[96:99]
    v_exp_f32 v36, v92
    v_exp_f32 v37, v93
    v_mfma_f32_16x16x32_bf16 v[96:99], v[204:207], v[68:71], v[96:99]
    v_exp_f32 v38, v94
    v_mfma_f32_16x16x32_bf16 v[96:99], v[212:215], v[192:195], v[96:99]
    v_exp_f32 v39, v95
    v_fma_f32 v36, v36, s42, s42
    v_mfma_f32_16x16x32_bf16 v[100:103], v[176:179], v[156:159], v[100:103]
    ds_read_b128 v[156:159], v6 offset:0
    v_fma_f32 v37, v37, s42, s42
    v_fma_f32 v38, v38, s42, s42
    v_mfma_f32_16x16x32_bf16 v[100:103], v[180:183], v[164:167], v[100:103]
    v_fma_f32 v39, v39, s42, s42
    v_rcp_f32 v36, v36
    v_mfma_f32_16x16x32_bf16 v[100:103], v[184:187], v[208:211], v[100:103]
    v_rcp_f32 v37, v37
    v_rcp_f32 v38, v38
    v_mfma_f32_16x16x32_bf16 v[100:103], v[188:191], v[52:55], v[100:103]
    ds_read_b128 v[52:55], v3 offset:33664
    v_rcp_f32 v39, v39
    v_mfma_f32_16x16x32_bf16 v[100:103], v[40:43], v[60:63], v[100:103]
    v_mul_f32 v36, v36, v92
    v_mul_f32 v37, v37, v93
    v_mfma_f32_16x16x32_bf16 v[100:103], v[44:47], v[148:151], v[100:103]
    v_mul_f32 v38, v38, v94
    v_mul_f32 v39, v39, v95
    ds_write_b64 v1, v[88:89] offset:12288
    v_mfma_f32_16x16x32_bf16 v[100:103], v[232:235], v[200:203], v[100:103]
    v_cvt_pk_bf16_f32 v92, v36, v37
    v_mfma_f32_16x16x32_bf16 v[100:103], v[240:243], v[64:67], v[100:103]
    v_cvt_pk_bf16_f32 v93, v38, v39
    ds_write_b64 v11, v[92:93] offset:12288
    v_mfma_f32_16x16x32_bf16 v[100:103], v[248:251], v[172:175], v[100:103]
    v_fma_f32 v96, v96, v16, v24
    v_fma_f32 v97, v97, v17, v25
    v_mfma_f32_16x16x32_bf16 v[100:103], v[252:255], v[140:143], v[100:103]
    ds_read_b128 v[200:203], v6 offset:33664
    v_fma_f32 v98, v98, v18, v26
    v_fma_f32 v99, v99, v19, v27
    v_mfma_f32_16x16x32_bf16 v[100:103], v[228:231], v[68:71], v[100:103]
    v_exp_f32 v32, v96
    v_exp_f32 v33, v97
    v_mfma_f32_16x16x32_bf16 v[100:103], v[244:247], v[192:195], v[100:103]
    v_exp_f32 v34, v98
    v_mfma_f32_16x16x32_bf16 v[104:107], v[128:131], v[164:167], v[104:107]
    v_exp_f32 v35, v99
    v_fma_f32 v32, v32, s42, s42
    v_mfma_f32_16x16x32_bf16 v[104:107], v[136:139], v[208:211], v[104:107]
    v_fma_f32 v33, v33, s42, s42
    v_fma_f32 v34, v34, s42, s42
    v_fma_f32 v35, v35, s42, s42
    v_mfma_f32_16x16x32_bf16 v[104:107], v[144:147], v[72:75], v[104:107]
    s_waitcnt lgkmcnt(1)
    s_barrier
    v_rcp_f32 v32, v32
    v_rcp_f32 v33, v33
    v_mfma_f32_16x16x32_bf16 v[104:107], v[152:155], v[60:63], v[104:107]
    v_rcp_f32 v34, v34
    v_mfma_f32_16x16x32_bf16 v[104:107], v[160:163], v[148:151], v[104:107]
    v_rcp_f32 v35, v35
    v_mul_f32 v32, v32, v96
    v_mfma_f32_16x16x32_bf16 v[104:107], v[168:171], v[76:79], v[104:107]
    v_mul_f32 v33, v33, v97
    v_mul_f32 v34, v34, v98
    v_mul_f32 v35, v35, v99
    v_mfma_f32_16x16x32_bf16 v[104:107], v[48:51], v[64:67], v[104:107]
    v_cvt_pk_bf16_f32 v96, v32, v33
    v_cvt_pk_bf16_f32 v97, v34, v35
    v_fma_f32 v100, v100, v20, v28
    v_mfma_f32_16x16x32_bf16 v[104:107], v[56:59], v[172:175], v[104:107]
    v_fma_f32 v101, v101, v21, v29
    v_fma_f32 v102, v102, v22, v30
    v_fma_f32 v103, v103, v23, v31
    v_mfma_f32_16x16x32_bf16 v[104:107], v[12:15], v[216:219], v[104:107]
    v_exp_f32 v36, v100
    v_exp_f32 v37, v101
    v_mfma_f32_16x16x32_bf16 v[104:107], v[196:199], v[68:71], v[104:107]
    v_exp_f32 v38, v102
    v_mfma_f32_16x16x32_bf16 v[104:107], v[204:207], v[192:195], v[104:107]
    v_exp_f32 v39, v103
    v_fma_f32 v36, v36, s42, s42
    v_mfma_f32_16x16x32_bf16 v[104:107], v[212:215], v[224:227], v[104:107]
    v_fma_f32 v37, v37, s42, s42
    v_fma_f32 v38, v38, s42, s42
    v_fma_f32 v39, v39, s42, s42
    v_mfma_f32_16x16x32_bf16 v[108:111], v[176:179], v[164:167], v[108:111]
    v_rcp_f32 v36, v36
    v_rcp_f32 v37, v37
    v_mfma_f32_16x16x32_bf16 v[108:111], v[180:183], v[208:211], v[108:111]
    v_rcp_f32 v38, v38
    v_mfma_f32_16x16x32_bf16 v[108:111], v[184:187], v[72:75], v[108:111]
    v_rcp_f32 v39, v39
    v_mul_f32 v36, v36, v100
    v_mfma_f32_16x16x32_bf16 v[108:111], v[188:191], v[60:63], v[108:111]
    v_mul_f32 v37, v37, v101
    v_mul_f32 v38, v38, v102
    v_mul_f32 v39, v39, v103
    v_mfma_f32_16x16x32_bf16 v[108:111], v[40:43], v[148:151], v[108:111]
    ds_write_b64 v1, v[96:97] offset:16384
    v_mfma_f32_16x16x32_bf16 v[108:111], v[44:47], v[76:79], v[108:111]
    v_cvt_pk_bf16_f32 v100, v36, v37
    v_cvt_pk_bf16_f32 v101, v38, v39
    ds_write_b64 v11, v[100:101] offset:16384
    v_mfma_f32_16x16x32_bf16 v[108:111], v[232:235], v[64:67], v[108:111]
    v_fma_f32 v104, v104, v16, v24
    v_mfma_f32_16x16x32_bf16 v[108:111], v[240:243], v[172:175], v[108:111]
    v_fma_f32 v105, v105, v17, v25
L_touch3:
    s_cbranch_scc0 L_compute
    v_fma_f32 v106, v106, v18, v26
    v_fma_f32 v107, v107, v19, v27
    v_mfma_f32_16x16x32_bf16 v[108:111], v[248:251], v[216:219], v[108:111]
    v_exp_f32 v32, v104
    v_exp_f32 v33, v105
    v_mfma_f32_16x16x32_bf16 v[108:111], v[252:255], v[68:71], v[108:111]
    v_exp_f32 v34, v106
    v_mfma_f32_16x16x32_bf16 v[108:111], v[228:231], v[192:195], v[108:111]
    v_exp_f32 v35, v107
    v_fma_f32 v32, v32, s42, s42
    v_mfma_f32_16x16x32_bf16 v[108:111], v[244:247], v[224:227], v[108:111]
    v_fma_f32 v33, v33, s42, s42
    v_fma_f32 v34, v34, s42, s42
    v_fma_f32 v35, v35, s42, s42
    v_mfma_f32_16x16x32_bf16 v[112:115], v[128:131], v[208:211], v[112:115]
    s_waitcnt lgkmcnt(0)
    s_barrier
    v_rcp_f32 v32, v32
    v_rcp_f32 v33, v33
    v_mfma_f32_16x16x32_bf16 v[112:115], v[136:139], v[72:75], v[112:115]
    v_rcp_f32 v34, v34
    v_mfma_f32_16x16x32_bf16 v[112:115], v[144:147], v[236:239], v[112:115]
    v_rcp_f32 v35, v35
    v_mul_f32 v32, v32, v104
    v_mfma_f32_16x16x32_bf16 v[112:115], v[152:155], v[148:151], v[112:115]
    v_mul_f32 v33, v33, v105
    v_mul_f32 v34, v34, v106
    v_mul_f32 v35, v35, v107
    v_mfma_f32_16x16x32_bf16 v[112:115], v[160:163], v[76:79], v[112:115]
    v_cvt_pk_bf16_f32 v104, v32, v33
    v_cvt_pk_bf16_f32 v105, v34, v35
    v_fma_f32 v108, v108, v20, v28
    v_mfma_f32_16x16x32_bf16 v[112:115], v[168:171], v[220:223], v[112:115]
    v_fma_f32 v109, v109, v21, v29
    v_fma_f32 v110, v110, v22, v30
    v_fma_f32 v111, v111, v23, v31
    v_mfma_f32_16x16x32_bf16 v[112:115], v[48:51], v[172:175], v[112:115]
    v_exp_f32 v36, v108
    v_exp_f32 v37, v109
    v_mfma_f32_16x16x32_bf16 v[112:115], v[56:59], v[216:219], v[112:115]
    v_exp_f32 v38, v110
    v_mfma_f32_16x16x32_bf16 v[112:115], v[12:15], v[80:83], v[112:115]
    v_exp_f32 v39, v111
    v_fma_f32 v36, v36, s42, s42
    v_mfma_f32_16x16x32_bf16 v[112:115], v[196:199], v[192:195], v[112:115]
    v_fma_f32 v37, v37, s42, s42
    v_fma_f32 v38, v38, s42, s42
    v_mfma_f32_16x16x32_bf16 v[112:115], v[204:207], v[224:227], v[112:115]
    v_fma_f32 v39, v39, s42, s42
    v_rcp_f32 v36, v36
    v_mfma_f32_16x16x32_bf16 v[112:115], v[212:215], v[84:87], v[112:115]
    v_rcp_f32 v37, v37
    v_rcp_f32 v38, v38
    v_mfma_f32_16x16x32_bf16 v[116:119], v[176:179], v[208:211], v[116:119]
    v_rcp_f32 v39, v39
    v_mfma_f32_16x16x32_bf16 v[116:119], v[180:183], v[72:75], v[116:119]
    v_mul_f32 v36, v36, v108
    v_mul_f32 v37, v37, v109
    v_mul_f32 v38, v38, v110
    v_mfma_f32_16x16x32_bf16 v[116:119], v[184:187], v[236:239], v[116:119]
    v_mul_f32 v39, v39, v111
    ds_write_b64 v1, v[104:105] offset:20480
    v_mfma_f32_16x16x32_bf16 v[116:119], v[188:191], v[148:151], v[116:119]
    v_cvt_pk_bf16_f32 v108, v36, v37
    v_cvt_pk_bf16_f32 v109, v38, v39
    v_mfma_f32_16x16x32_bf16 v[116:119], v[40:43], v[76:79], v[116:119]
    ds_write_b64 v11, v[108:109] offset:20480
    v_mfma_f32_16x16x32_bf16 v[116:119], v[44:47], v[220:223], v[116:119]
    v_fma_f32 v112, v112, v16, v24
    v_fma_f32 v113, v113, v17, v25
    v_fma_f32 v114, v114, v18, v26
    v_mfma_f32_16x16x32_bf16 v[116:119], v[232:235], v[172:175], v[116:119]
    v_fma_f32 v115, v115, v19, v27
    v_exp_f32 v32, v112
    v_mfma_f32_16x16x32_bf16 v[116:119], v[240:243], v[216:219], v[116:119]
    v_exp_f32 v33, v113
    v_exp_f32 v34, v114
    v_mfma_f32_16x16x32_bf16 v[116:119], v[248:251], v[80:83], v[116:119]
    v_exp_f32 v35, v115
    v_mfma_f32_16x16x32_bf16 v[116:119], v[252:255], v[192:195], v[116:119]
    v_fma_f32 v32, v32, s42, s42
    v_fma_f32 v33, v33, s42, s42
    v_fma_f32 v34, v34, s42, s42
    v_mfma_f32_16x16x32_bf16 v[116:119], v[228:231], v[224:227], v[116:119]
    v_fma_f32 v35, v35, s42, s42
    v_rcp_f32 v32, v32
    v_mfma_f32_16x16x32_bf16 v[116:119], v[244:247], v[84:87], v[116:119]
    s_waitcnt lgkmcnt(0)
    s_barrier
    v_rcp_f32 v33, v33
    v_rcp_f32 v34, v34
    v_mfma_f32_16x16x32_bf16 v[120:123], v[128:131], v[72:75], v[120:123]
    v_rcp_f32 v35, v35
    v_mfma_f32_16x16x32_bf16 v[120:123], v[136:139], v[236:239], v[120:123]
    v_mul_f32 v32, v32, v112
    v_mul_f32 v33, v33, v113
    v_mul_f32 v34, v34, v114
    v_mfma_f32_16x16x32_bf16 v[120:123], v[144:147], v[132:135], v[120:123]
    v_mul_f32 v35, v35, v115
    v_cvt_pk_bf16_f32 v112, v32, v33
    v_cvt_pk_bf16_f32 v113, v34, v35
    v_mfma_f32_16x16x32_bf16 v[120:123], v[152:155], v[76:79], v[120:123]
    v_fma_f32 v116, v116, v20, v28
    v_fma_f32 v117, v117, v21, v29
    v_fma_f32 v118, v118, v22, v30
    v_mfma_f32_16x16x32_bf16 v[120:123], v[160:163], v[220:223], v[120:123]
    v_fma_f32 v119, v119, v23, v31
    v_exp_f32 v36, v116
    v_mfma_f32_16x16x32_bf16 v[120:123], v[168:171], v[156:159], v[120:123]
    v_exp_f32 v37, v117
    v_exp_f32 v38, v118
    v_mfma_f32_16x16x32_bf16 v[120:123], v[48:51], v[216:219], v[120:123]
    v_exp_f32 v39, v119
    v_mfma_f32_16x16x32_bf16 v[120:123], v[56:59], v[80:83], v[120:123]
    v_fma_f32 v36, v36, s42, s42
    v_fma_f32 v37, v37, s42, s42
    v_fma_f32 v38, v38, s42, s42
    v_mfma_f32_16x16x32_bf16 v[120:123], v[12:15], v[52:55], v[120:123]
    v_fma_f32 v39, v39, s42, s42
    v_rcp_f32 v36, v36
    v_mfma_f32_16x16x32_bf16 v[120:123], v[196:199], v[224:227], v[120:123]
    v_rcp_f32 v37, v37
    v_rcp_f32 v38, v38
    v_mfma_f32_16x16x32_bf16 v[120:123], v[204:207], v[84:87], v[120:123]
    v_rcp_f32 v39, v39
    v_mfma_f32_16x16x32_bf16 v[120:123], v[212:215], v[200:203], v[120:123]
    v_mul_f32 v36, v36, v116
    v_mul_f32 v37, v37, v117
    v_mul_f32 v38, v38, v118
    v_mfma_f32_16x16x32_bf16 v[124:127], v[176:179], v[72:75], v[124:127]
    v_mul_f32 v39, v39, v119
    ds_write_b64 v1, v[112:113] offset:24576
    v_mfma_f32_16x16x32_bf16 v[124:127], v[180:183], v[236:239], v[124:127]
    v_cvt_pk_bf16_f32 v116, v36, v37
    v_cvt_pk_bf16_f32 v117, v38, v39
    v_mfma_f32_16x16x32_bf16 v[124:127], v[184:187], v[132:135], v[124:127]
    ds_write_b64 v11, v[116:117] offset:24576
    v_mfma_f32_16x16x32_bf16 v[124:127], v[188:191], v[76:79], v[124:127]
    v_fma_f32 v120, v120, v16, v24
    v_fma_f32 v121, v121, v17, v25
    v_fma_f32 v122, v122, v18, v26
    v_mfma_f32_16x16x32_bf16 v[124:127], v[40:43], v[220:223], v[124:127]
    v_fma_f32 v123, v123, v19, v27
    v_exp_f32 v32, v120
    v_mfma_f32_16x16x32_bf16 v[124:127], v[44:47], v[156:159], v[124:127]
    v_exp_f32 v33, v121
    v_exp_f32 v34, v122
    v_mfma_f32_16x16x32_bf16 v[124:127], v[232:235], v[216:219], v[124:127]
    v_exp_f32 v35, v123
    v_mfma_f32_16x16x32_bf16 v[124:127], v[240:243], v[80:83], v[124:127]
    v_fma_f32 v32, v32, s42, s42
    v_fma_f32 v33, v33, s42, s42
    v_fma_f32 v34, v34, s42, s42
    v_mfma_f32_16x16x32_bf16 v[124:127], v[248:251], v[52:55], v[124:127]
    v_fma_f32 v35, v35, s42, s42
    v_rcp_f32 v32, v32
    v_mfma_f32_16x16x32_bf16 v[124:127], v[252:255], v[224:227], v[124:127]
    s_waitcnt lgkmcnt(0)
    s_barrier
    v_rcp_f32 v33, v33
    v_rcp_f32 v34, v34
    v_mfma_f32_16x16x32_bf16 v[124:127], v[228:231], v[84:87], v[124:127]
    v_rcp_f32 v35, v35
    v_mfma_f32_16x16x32_bf16 v[124:127], v[244:247], v[200:203], v[124:127]
    v_mul_f32 v32, v32, v120
    v_mul_f32 v33, v33, v121
    v_mul_f32 v34, v34, v122
    v_mul_f32 v35, v35, v123
    v_cvt_pk_bf16_f32 v120, v32, v33
    v_cvt_pk_bf16_f32 v121, v34, v35
    s_nop 1
    v_pk_fma_f32 v[124:125], v[124:125], v[20:21], v[28:29]
    v_pk_fma_f32 v[126:127], v[126:127], v[22:23], v[30:31]
    v_exp_f32 v36, v124
    v_exp_f32 v37, v125
    v_exp_f32 v38, v126
    v_exp_f32 v39, v127
    v_pk_fma_f32 v[36:37], v[36:37], s[42:43], s[42:43]
    v_pk_fma_f32 v[38:39], v[38:39], s[42:43], s[42:43]
    v_rcp_f32 v36, v36
    v_rcp_f32 v37, v37
    v_rcp_f32 v38, v38
    v_rcp_f32 v39, v39
    v_pk_mul_f32 v[36:37], v[36:37], v[124:125]
    v_pk_mul_f32 v[38:39], v[38:39], v[126:127]
    ds_write_b64 v1, v[120:121] offset:28672
    v_cvt_pk_bf16_f32 v124, v36, v37
    v_cvt_pk_bf16_f32 v125, v38, v39
    ds_write_b64 v11, v[124:125] offset:28672
    s_waitcnt lgkmcnt(0)
    s_barrier
L_tail_end:
    s_endpgm
L_end:
    s_endpgm
.section .rodata,"a"
.p2align 6
.amdhsa_kernel standalone__batchnorm__prompt_kernel
  .amdhsa_next_free_vgpr 256
  .amdhsa_next_free_sgpr 96
  .amdhsa_accum_offset 256
  .amdhsa_group_segment_fixed_size 0
  .amdhsa_kernarg_size 72
  .amdhsa_user_sgpr_count 2
  .amdhsa_user_sgpr_kernarg_segment_ptr 1
  .amdhsa_system_sgpr_workgroup_id_x 1
.end_amdhsa_kernel
```
